```python
import torch

def _softmax(x, axis=-1):
    return torch.softmax(x, dim=axis)

def _gelu(x):
    return torch.nn.functional.gelu(x, approximate='tanh')

def _silu(x):
    return torch.nn.functional.silu(x)

def _sigmoid(x):
    return torch.sigmoid(x)

def _layernorm(x, axis=-1, eps=1e-05):
    m = x.mean(dim=axis, keepdim=True)
    v = x.var(dim=axis, keepdim=True, unbiased=False)
    return (x - m) / torch.sqrt(v + eps)

def _scatter_add(tgt, idx, src, axis=0):
    return tgt.clone().index_add_(axis, idx, src)

def _segment_sum(src, seg, n):
    out = torch.zeros((n,) + src.shape[1:], dtype=src.dtype)
    return out.index_add_(0, seg, src)

def _pad(x, pw):
    flat = tuple((v for pair in reversed(pw) for v in pair))
    return torch.nn.functional.pad(x, flat)
kernel_name = 'adaLN_cond__ssm_conv_s4d__swiglu_ffn__prompt'

def setup_inputs():

    _w = lambda a: (lambda t: t.to(torch.bfloat16) if t.is_floating_point() else t)(torch.as_tensor(a))

    def _A_setup():
        Bsz, L, D, N = (1, 2048, 640, 192)
        return {'u': _w((lambda *s: torch.randn(*s, dtype=torch.bfloat16) * 0.05)(Bsz, L, D)), 'log_A_real': _w((lambda *s: torch.randn(*s, dtype=torch.bfloat16) * 3.2)(D, N) * 0.5), 'A_imag': _w((lambda *s: torch.randn(*s, dtype=torch.bfloat16) * 0.1)(D, N) * 3.14), 'C_real': _w((lambda *s: torch.randn(*s, dtype=torch.bfloat16) * 0.4)(D, N) / N ** 0.5), 'C_imag': _w((lambda *s: torch.randn(*s, dtype=torch.bfloat16) * 0.4)(D, N) / N ** 0.5), 'log_dt': _w((lambda *s: torch.randn(*s, dtype=torch.bfloat16) * 0.1)(D) * 0.5 - 4.0), 'D_skip': _w((lambda *s: torch.randn(*s, dtype=torch.bfloat16) * 0.2)(D))}
    _A_in = _A_setup()

    def _B_setup():
        B, S, D, F = (1, 2048, 640, 1536)
        return {'x': _w((lambda *s: torch.randn(*s, dtype=torch.bfloat16) * 0.05)(B, S, D)), 'w_gate': _w((lambda *s: torch.randn(*s, dtype=torch.bfloat16) * 0.05)(D, F)), 'w_up': _w((lambda *s: torch.randn(*s, dtype=torch.bfloat16) * 0.05)(D, F)), 'w_down': _w((lambda *s: torch.randn(*s, dtype=torch.bfloat16) * 0.05)(F, D))}
    _B_in = _B_setup()
    return {'A_u': _A_in['u'], 'A_log_A_real': _A_in['log_A_real'], 'A_A_imag': _A_in['A_imag'], 'A_C_real': _A_in['C_real'], 'A_C_imag': _A_in['C_imag'], 'A_log_dt': _A_in['log_dt'], 'A_D_skip': _A_in['D_skip'], 'B_x': _B_in['x'], 'B_w_gate': _B_in['w_gate'], 'B_w_up': _B_in['w_up'], 'B_w_down': _B_in['w_down'], 'c': _w((lambda *s: torch.randn(*s, dtype=torch.bfloat16) * 0.1)(1, 640) * 8.0), 'w_mod': _w((lambda *s: torch.randn(*s, dtype=torch.bfloat16) * 0.1)(640, 6 * 640) * 640 ** (-0.5) * 8.0)}

def reference(A_u, A_log_A_real, A_A_imag, A_C_real, A_C_imag, A_log_dt, A_D_skip, B_x, B_w_gate, B_w_up, B_w_down, c, w_mod):

    def _A_ref(u, log_A_real, A_imag, C_real, C_imag, log_dt, D_skip):
        L = u.shape[1]
        dt = torch.exp(log_dt)
        A = -torch.exp(log_A_real) + 1j * A_imag
        C = (C_real + 1j * C_imag) * dt[:, None]
        pos = (lambda x, dt: x.to(dt))(torch.arange(L), log_dt.dtype)
        P = torch.exp((A * dt[:, None])[:, :, None] * pos[None, None, :])
        K = 2.0 * torch.einsum('dn,dnl->dl', C, P).real
        L2 = 2 * L
        u_t = (lambda x, *d: x.permute(*d))(u, 0, 2, 1)
        Kf = (lambda x, *a, **k: torch.fft.rfft(x.float(), *a, **k))(K, L2)
        Uf = (lambda x, *a, **k: torch.fft.rfft(x.float(), *a, **k))(u_t, L2)
        y = (lambda x, *a, **k: torch.fft.irfft(x, *a, **k).to(torch.bfloat16))(Uf * Kf[None, :, :], L2)[:, :, :L]
        y = (lambda x, *d: x.permute(*d))(y, 0, 2, 1)
        return y + u * D_skip[None, None, :]

    def _B_ref(x, w_gate, w_up, w_down):
        g = _silu(x @ w_gate)
        u = x @ w_up
        return g * u @ w_down
    x = A_u
    mod = (_silu(c) @ w_mod).reshape(c.shape[0], 6, 1, -1)
    sa, ca, ga, sb, cb, gb = (mod[:, 0].clone(), mod[:, 1].clone(), mod[:, 2].clone(), mod[:, 3].clone(), mod[:, 4].clone(), mod[:, 5].clone())
    h = _layernorm(x, axis=-1) * (1 + ca) + sa
    x = x + ga * _A_ref(h, A_log_A_real, A_A_imag, A_C_real, A_C_imag, A_log_dt, A_D_skip)
    h = _layernorm(x, axis=-1) * (1 + cb) + sb
    x = x + gb * _B_ref(h, B_w_gate, B_w_up, B_w_down)
    return x
```

```asm
; @launch kernel=k12_prep_kernel grid=(396,1,1) block=(256,1,1) lds=81920
; @launch kernel=k3_gemm1_kernel grid=(256,1,1) block=(256,1,1) lds=124928
; @launch kernel=k4_gemm2_kernel grid=(256,1,1) block=(256,1,1) lds=73728
.amdgcn_target "amdgcn-amd-amdhsa--gfx950"
.text
.globl k12_prep_kernel
.p2align 8
.type k12_prep_kernel,@function
k12_prep_kernel:
    s_sub_u32 s3, s2, 0
    s_cmp_lt_u32 s3, 160
    s_cbranch_scc1 K12_CONV
    s_sub_u32 s3, s2, 160
    s_cmp_lt_u32 s3, 60
    s_cbranch_scc1 K12_GEMV
    s_sub_u32 s3, s2, 220
    s_cmp_lt_u32 s3, 32
    s_cbranch_scc1 K12_STATS
    s_sub_u32 s3, s2, 252
    s_cmp_lt_u32 s3, 48
    s_cbranch_scc1 K12_WD
    s_sub_u32 s3, s2, 300
    s_cmp_lt_u32 s3, 96
    s_cbranch_scc1 K12_WPREP
K12_EXIT:
    s_endpgm
K12_CONV:
    v_and_b32 v1, 63, v0
    v_lshrrev_b32 v2, 6, v0
    s_load_dwordx2 s[4:5], s[0:1], 8
    s_load_dwordx2 s[8:9], s[0:1], 16
    s_load_dwordx2 s[12:13], s[0:1], 24
    s_load_dwordx2 s[16:17], s[0:1], 32
    s_load_dwordx2 s[20:21], s[0:1], 40
    s_load_dwordx2 s[28:29], s[0:1], 120
    v_readfirstlane_b32 s30, v2
    v_lshlrev_b32 v2, 1, v1
    s_sub_u32 s37, s2, 0
    s_and_b32 s38, s37, 7
    s_lshr_b32 s37, s37, 3
    s_mul_i32 s38, s38, 20
    s_add_u32 s37, s37, s38
    s_lshl_b32 s31, s37, 2
    s_load_dwordx2 s[40:41], s[0:1], 0
    s_load_dwordx2 s[44:45], s[0:1], 112
    s_load_dwordx2 s[60:61], s[0:1], 48
    s_add_u32 s31, s31, s30
    s_mul_i32 s32, s31, 384
    s_mul_i32 s33, s30, 20480
    s_lshl_b32 s34, s31, 1
    s_mov_b32 s6, 245760
    s_mov_b32 s7, 0x00020000
    s_mov_b32 s10, 245760
    s_mov_b32 s11, 0x00020000
    s_mov_b32 s14, 245760
    s_mov_b32 s15, 0x00020000
    s_mov_b32 s18, 245760
    s_mov_b32 s19, 0x00020000
    s_mov_b32 s22, 1280
    s_mov_b32 s23, 0x00020000
    s_waitcnt lgkmcnt(0)
    v_mov_b32 v3, 0
    buffer_load_ushort v22, v3, s[20:23], s34 offen
    buffer_load_ushort v10, v2, s[4:7], s32 offen offset:0
    buffer_load_ushort v13, v2, s[8:11], s32 offen offset:0
    buffer_load_ushort v16, v2, s[12:15], s32 offen offset:0
    buffer_load_ushort v19, v2, s[16:19], s32 offen offset:0
    buffer_load_ushort v11, v2, s[4:7], s32 offen offset:128
    buffer_load_ushort v14, v2, s[8:11], s32 offen offset:128
    buffer_load_ushort v17, v2, s[12:15], s32 offen offset:128
    buffer_load_ushort v20, v2, s[16:19], s32 offen offset:128
    buffer_load_ushort v12, v2, s[4:7], s32 offen offset:256
    buffer_load_ushort v15, v2, s[8:11], s32 offen offset:256
    buffer_load_ushort v18, v2, s[12:15], s32 offen offset:256
    buffer_load_ushort v21, v2, s[16:19], s32 offen offset:256
    s_mov_b32 s42, 2621440
    s_mov_b32 s43, 0x00020000
    s_mov_b32 s46, 256
    s_mov_b32 s47, 0x00020000
    s_lshl_b32 s38, s37, 3
    s_add_u32 s39, s38, 5120
    v_mul_u32_u24 v4, 10240, v0
    buffer_load_dwordx2 v[192:193], v4, s[40:43], s38 offen offset:0
    buffer_load_dwordx2 v[194:195], v4, s[40:43], s38 offen offset:1280
    buffer_load_dwordx2 v[196:197], v4, s[40:43], s38 offen offset:2560
    buffer_load_dwordx2 v[198:199], v4, s[40:43], s38 offen offset:3840
    buffer_load_dwordx2 v[200:201], v4, s[40:43], s39 offen offset:0
    buffer_load_dwordx2 v[202:203], v4, s[40:43], s39 offen offset:1280
    buffer_load_dwordx2 v[204:205], v4, s[40:43], s39 offen offset:2560
    buffer_load_dwordx2 v[206:207], v4, s[40:43], s39 offen offset:3840
    s_add_u32 s60, s60, s38
    s_addc_u32 s61, s61, 0
    s_load_dwordx2 s[62:63], s[60:61], 0
    s_add_u32 s48, s28, 0
    s_addc_u32 s49, s29, 0
    s_mov_b32 s50, 15360
    s_mov_b32 s51, 0x00020000
    s_add_u32 s52, s28, 65536
    s_addc_u32 s53, s29, 0
    s_mov_b32 s54, 16384
    s_mov_b32 s55, 0x00020000
    s_add_u32 s56, s28, 16777216
    s_addc_u32 s57, s29, 0
    s_mov_b32 s58, 2621440
    s_mov_b32 s59, 0x00020000
    v_lshlrev_b32 v4, 3, v1
    v_cvt_f32_u32 v4, v4
    s_sub_u32 s35, s33, 34048
    v_cmp_le_u32 vcc, 48, v1
    v_lshlrev_b32 v5, 4, v1
    v_sub_f32 v6, 0x44ffe000, v4
    v_sub_f32 v7, 0x44ffc000, v4
    v_cvt_pk_bf16_f32 v8, v6, v7
    v_and_b32 v6, 0xffff, v8
    v_lshrrev_b32 v7, 16, v8
    v_lshl_add_u32 v32, v6, 1, s35
    v_lshl_add_u32 v33, v7, 1, s35
    v_sub_f32 v6, 0x44ffa000, v4
    v_sub_f32 v7, 0x44ff8000, v4
    v_cvt_pk_bf16_f32 v8, v6, v7
    v_and_b32 v6, 0xffff, v8
    v_lshrrev_b32 v7, 16, v8
    v_lshl_add_u32 v34, v6, 1, s35
    v_lshl_add_u32 v35, v7, 1, s35
    v_sub_f32 v6, 0x44ff6000, v4
    v_sub_f32 v7, 0x44ff4000, v4
    v_cvt_pk_bf16_f32 v8, v6, v7
    v_and_b32 v6, 0xffff, v8
    v_lshrrev_b32 v7, 16, v8
    v_lshl_add_u32 v36, v6, 1, s35
    v_lshl_add_u32 v37, v7, 1, s35
    v_sub_f32 v6, 0x44ff2000, v4
    v_sub_f32 v7, 0x44ff0000, v4
    v_cvt_pk_bf16_f32 v8, v6, v7
    v_and_b32 v6, 0xffff, v8
    v_lshrrev_b32 v7, 16, v8
    v_lshl_add_u32 v38, v6, 1, s35
    v_lshl_add_u32 v39, v7, 1, s35
    v_sub_f32 v6, 0x44bfe000, v4
    v_sub_f32 v7, 0x44bfc000, v4
    v_cvt_pk_bf16_f32 v8, v6, v7
    v_and_b32 v6, 0xffff, v8
    v_lshrrev_b32 v7, 16, v8
    v_lshl_add_u32 v40, v6, 1, s35
    v_lshl_add_u32 v41, v7, 1, s35
    v_sub_f32 v6, 0x44bfa000, v4
    v_sub_f32 v7, 0x44bf8000, v4
    v_cvt_pk_bf16_f32 v8, v6, v7
    v_and_b32 v6, 0xffff, v8
    v_lshrrev_b32 v7, 16, v8
    v_lshl_add_u32 v42, v6, 1, s35
    v_lshl_add_u32 v43, v7, 1, s35
    v_sub_f32 v6, 0x44bf6000, v4
    v_sub_f32 v7, 0x44bf4000, v4
    v_cvt_pk_bf16_f32 v8, v6, v7
    v_and_b32 v6, 0xffff, v8
    v_lshrrev_b32 v7, 16, v8
    v_lshl_add_u32 v44, v6, 1, s35
    v_lshl_add_u32 v45, v7, 1, s35
    v_sub_f32 v6, 0x44bf2000, v4
    v_sub_f32 v7, 0x44bf0000, v4
    v_cvt_pk_bf16_f32 v8, v6, v7
    v_and_b32 v6, 0xffff, v8
    v_lshrrev_b32 v7, 16, v8
    v_lshl_add_u32 v46, v6, 1, s35
    v_lshl_add_u32 v47, v7, 1, s35
    v_sub_f32 v6, 0x447fc000, v4
    v_sub_f32 v7, 0x447f8000, v4
    v_cvt_pk_bf16_f32 v8, v6, v7
    v_and_b32 v6, 0xffff, v8
    v_lshrrev_b32 v7, 16, v8
    v_lshl_add_u32 v48, v6, 1, s35
    v_lshl_add_u32 v49, v7, 1, s35
    v_sub_f32 v6, 0x447f4000, v4
    v_sub_f32 v7, 0x447f0000, v4
    v_cvt_pk_bf16_f32 v8, v6, v7
    v_and_b32 v6, 0xffff, v8
    v_lshrrev_b32 v7, 16, v8
    v_lshl_add_u32 v50, v6, 1, s35
    v_lshl_add_u32 v51, v7, 1, s35
    v_sub_f32 v6, 0x447ec000, v4
    v_sub_f32 v7, 0x447e8000, v4
    v_cvt_pk_bf16_f32 v8, v6, v7
    v_and_b32 v6, 0xffff, v8
    v_lshrrev_b32 v7, 16, v8
    v_lshl_add_u32 v52, v6, 1, s35
    v_lshl_add_u32 v53, v7, 1, s35
    v_sub_f32 v6, 0x447e4000, v4
    v_sub_f32 v7, 0x447e0000, v4
    v_cvt_pk_bf16_f32 v8, v6, v7
    v_and_b32 v6, 0xffff, v8
    v_lshrrev_b32 v7, 16, v8
    v_lshl_add_u32 v54, v6, 1, s35
    v_lshl_add_u32 v55, v7, 1, s35
    v_sub_f32 v6, 0x43ff8000, v4
    v_sub_f32 v7, 0x43ff0000, v4
    v_cvt_pk_bf16_f32 v8, v6, v7
    v_and_b32 v6, 0xffff, v8
    v_lshrrev_b32 v7, 16, v8
    v_lshl_add_u32 v56, v6, 1, s35
    v_lshl_add_u32 v57, v7, 1, s35
    s_add_u32 s36, s33, 1022
    v_sub_u32 v6, s36, v5
    v_cndmask_b32 v56, v56, v6, vcc
    s_add_u32 s36, s33, 1020
    v_sub_u32 v6, s36, v5
    v_cndmask_b32 v57, v57, v6, vcc
    v_sub_f32 v6, 0x43fe8000, v4
    v_sub_f32 v7, 0x43fe0000, v4
    v_cvt_pk_bf16_f32 v8, v6, v7
    v_and_b32 v6, 0xffff, v8
    v_lshrrev_b32 v7, 16, v8
    v_lshl_add_u32 v58, v6, 1, s35
    v_lshl_add_u32 v59, v7, 1, s35
    s_add_u32 s36, s33, 1018
    v_sub_u32 v6, s36, v5
    v_cndmask_b32 v58, v58, v6, vcc
    s_add_u32 s36, s33, 1016
    v_sub_u32 v6, s36, v5
    v_cndmask_b32 v59, v59, v6, vcc
    v_sub_f32 v6, 0x43fd8000, v4
    v_sub_f32 v7, 0x43fd0000, v4
    v_cvt_pk_bf16_f32 v8, v6, v7
    v_and_b32 v6, 0xffff, v8
    v_lshrrev_b32 v7, 16, v8
    v_lshl_add_u32 v60, v6, 1, s35
    v_lshl_add_u32 v61, v7, 1, s35
    s_add_u32 s36, s33, 1014
    v_sub_u32 v6, s36, v5
    v_cndmask_b32 v60, v60, v6, vcc
    s_add_u32 s36, s33, 1012
    v_sub_u32 v6, s36, v5
    v_cndmask_b32 v61, v61, v6, vcc
    v_sub_f32 v6, 0x43fc8000, v4
    v_sub_f32 v7, 0x43fc0000, v4
    v_cvt_pk_bf16_f32 v8, v6, v7
    v_and_b32 v6, 0xffff, v8
    v_lshrrev_b32 v7, 16, v8
    v_lshl_add_u32 v62, v6, 1, s35
    v_lshl_add_u32 v63, v7, 1, s35
    s_add_u32 s36, s33, 1010
    v_sub_u32 v6, s36, v5
    v_cndmask_b32 v62, v62, v6, vcc
    s_add_u32 s36, s33, 1008
    v_sub_u32 v6, s36, v5
    v_cndmask_b32 v63, v63, v6, vcc
    v_lshl_add_u32 v24, v1, 2, s33
    v_and_b32 v6, 31, v1
    v_mul_u32_u24 v6, 272, v6
    v_lshrrev_b32 v7, 5, v1
    v_lshl_add_u32 v6, v7, 4, v6
    v_add_u32 v25, s33, v6
    v_and_b32 v6, 31, v1
    v_lshrrev_b32 v7, 5, v1
    v_lshlrev_b32 v8, 4, v6
    v_lshl_add_u32 v8, v7, 3, v8
    v_add_u32 v26, s33, v8
    v_cmp_eq_u32 vcc, 1, v7
    v_lshlrev_b32 v8, 3, v6
    v_add_u32 v8, 512, v8
    v_lshlrev_b32 v9, 2, v6
    v_add_u32 v9, 768, v9
    v_cndmask_b32 v27, v8, v9, vcc
    v_add_u32 v8, 4, v8
    v_add_u32 v9, 128, v9
    v_cndmask_b32 v28, v8, v9, vcc
    v_add_u32 v27, s33, v27
    v_add_u32 v28, s33, v28
    v_lshlrev_b32 v8, 1, v6
    v_lshl_add_u32 v8, v7, 8, v8
    v_add_u32 v8, 1024, v8
    v_add_u32 v29, s33, v8
    v_mov_b32 v6, 0x3f80
    ds_write_b32 v24, v6 offset:5712
    s_waitcnt vmcnt(20)
    v_lshlrev_b32 v22, 16, v22
    v_mul_f32 v22, 0x3fb8aa3b, v22
    v_exp_f32 v22, v22
    s_nop 0
    v_cvt_pk_bf16_f32 v22, v22, v22
    v_lshlrev_b32 v23, 16, v22
    s_nop 0
    v_mul_f32 v30, 0x3fb8aa3b, v23
    v_mul_f32 v31, 0x3e22f983, v23
    v_add_f32 v9, v23, v23
    s_waitcnt vmcnt(8)
    v_lshlrev_b32 v10, 16, v10
    v_lshlrev_b32 v13, 16, v13
    v_mul_f32 v10, 0x3fb8aa3b, v10
    v_lshlrev_b32 v16, 16, v16
    v_exp_f32 v10, v10
    v_lshlrev_b32 v19, 16, v19
    v_mul_f32 v81, v13, v31
    v_cvt_pk_bf16_f32 v10, v10, v10
    v_mul_f32 v98, v16, v9
    v_lshlrev_b32 v10, 16, v10
    v_mul_f32 v99, v19, v9
    v_mul_f32 v80, v10, v30
    v_sub_f32 v99, 0, v99
    v_sub_f32 v80, 0, v80
    v_mul_f32 v114, 0x3f800000, v80
    v_mul_f32 v117, 0x3f800000, v81
    v_mul_f32 v115, 0x41000000, v80
    v_mul_f32 v118, 0x41000000, v81
    v_mul_f32 v116, 0x43800000, v80
    v_mul_f32 v119, 0x43800000, v81
    v_exp_f32 v114, v114
    v_fract_f32 v117, v117
    v_exp_f32 v115, v115
    v_fract_f32 v118, v118
    v_exp_f32 v116, v116
    v_fract_f32 v119, v119
    v_cos_f32 v82, v117
    v_sin_f32 v83, v117
    v_cos_f32 v84, v118
    v_sin_f32 v85, v118
    v_cos_f32 v86, v119
    v_sin_f32 v87, v119
    s_nop 0
    v_mul_f32 v82, v82, v114
    v_mul_f32 v83, v83, v114
    v_mul_f32 v84, v84, v115
    v_mul_f32 v85, v85, v115
    v_mul_f32 v86, v86, v116
    v_mul_f32 v87, v87, v116
    v_pk_mul_f32 v[96:97], v[82:83], v[82:83] op_sel:[0,0] op_sel_hi:[0,1]
    v_pk_fma_f32 v[88:89], v[82:83], v[82:83], v[96:97] op_sel:[1,1,0] op_sel_hi:[1,0,1] neg_lo:[0,1,0]
    s_nop 0
    v_pk_mul_f32 v[96:97], v[88:89], v[88:89] op_sel:[0,0] op_sel_hi:[0,1]
    v_pk_fma_f32 v[90:91], v[88:89], v[88:89], v[96:97] op_sel:[1,1,0] op_sel_hi:[1,0,1] neg_lo:[0,1,0]
    v_cvt_pk_bf16_f32 v110, v84, v85
    ds_write_b32 v24, v110 offset:5984
    v_cvt_pk_bf16_f32 v100, v98, v99
    v_pk_mul_f32 v[108:109], v[84:85], v[84:85] op_sel:[0,0] op_sel_hi:[0,1]
    ds_write_b32 v24, v100 offset:0
    v_pk_fma_f32 v[104:105], v[84:85], v[84:85], v[108:109] op_sel:[1,1,0] op_sel_hi:[1,0,1] neg_lo:[0,1,0]
    v_cvt_pk_bf16_f32 v111, v104, v105
    v_pk_mul_f32 v[96:97], v[98:99], v[82:83] op_sel:[0,0] op_sel_hi:[0,1] neg_hi:[0,1]
    ds_write_b32 v24, v111 offset:6256
    v_pk_fma_f32 v[92:93], v[98:99], v[82:83], v[96:97] op_sel:[1,1,0] op_sel_hi:[1,0,1]
    v_pk_mul_f32 v[108:109], v[104:105], v[84:85] op_sel:[0,0] op_sel_hi:[0,1]
    v_pk_fma_f32 v[106:107], v[104:105], v[84:85], v[108:109] op_sel:[1,1,0] op_sel_hi:[1,0,1] neg_lo:[0,1,0]
    v_cvt_pk_bf16_f32 v101, v92, v93
    v_cvt_pk_bf16_f32 v110, v106, v107
    ds_write_b32 v24, v101 offset:272
    ds_write_b32 v24, v110 offset:6528
    v_pk_mul_f32 v[108:109], v[106:107], v[84:85] op_sel:[0,0] op_sel_hi:[0,1]
    v_pk_mul_f32 v[96:97], v[92:93], v[82:83] op_sel:[0,0] op_sel_hi:[0,1] neg_hi:[0,1]
    v_pk_fma_f32 v[104:105], v[106:107], v[84:85], v[108:109] op_sel:[1,1,0] op_sel_hi:[1,0,1] neg_lo:[0,1,0]
    v_pk_fma_f32 v[94:95], v[92:93], v[82:83], v[96:97] op_sel:[1,1,0] op_sel_hi:[1,0,1]
    v_cvt_pk_bf16_f32 v111, v104, v105
    ds_write_b32 v24, v111 offset:6800
    v_cvt_pk_bf16_f32 v102, v94, v95
    v_pk_mul_f32 v[108:109], v[104:105], v[84:85] op_sel:[0,0] op_sel_hi:[0,1]
    ds_write_b32 v24, v102 offset:544
    v_pk_fma_f32 v[106:107], v[104:105], v[84:85], v[108:109] op_sel:[1,1,0] op_sel_hi:[1,0,1] neg_lo:[0,1,0]
    v_cvt_pk_bf16_f32 v110, v106, v107
    v_pk_mul_f32 v[96:97], v[94:95], v[82:83] op_sel:[0,0] op_sel_hi:[0,1] neg_hi:[0,1]
    ds_write_b32 v24, v110 offset:7072
    v_pk_fma_f32 v[92:93], v[94:95], v[82:83], v[96:97] op_sel:[1,1,0] op_sel_hi:[1,0,1]
    v_pk_mul_f32 v[108:109], v[106:107], v[84:85] op_sel:[0,0] op_sel_hi:[0,1]
    v_pk_fma_f32 v[104:105], v[106:107], v[84:85], v[108:109] op_sel:[1,1,0] op_sel_hi:[1,0,1] neg_lo:[0,1,0]
    v_cvt_pk_bf16_f32 v103, v92, v93
    v_cvt_pk_bf16_f32 v111, v104, v105
    ds_write_b32 v24, v103 offset:816
    ds_write_b32 v24, v111 offset:7344
    v_pk_mul_f32 v[108:109], v[104:105], v[84:85] op_sel:[0,0] op_sel_hi:[0,1]
    v_pk_mul_f32 v[96:97], v[92:93], v[82:83] op_sel:[0,0] op_sel_hi:[0,1] neg_hi:[0,1]
    v_pk_fma_f32 v[106:107], v[104:105], v[84:85], v[108:109] op_sel:[1,1,0] op_sel_hi:[1,0,1] neg_lo:[0,1,0]
    v_pk_fma_f32 v[94:95], v[92:93], v[82:83], v[96:97] op_sel:[1,1,0] op_sel_hi:[1,0,1]
    v_cvt_pk_bf16_f32 v110, v106, v107
    ds_write_b32 v24, v110 offset:7616
    v_cvt_pk_bf16_f32 v100, v94, v95
    v_pk_mul_f32 v[108:109], v[106:107], v[84:85] op_sel:[0,0] op_sel_hi:[0,1]
    ds_write_b32 v24, v100 offset:1088
    v_pk_fma_f32 v[104:105], v[106:107], v[84:85], v[108:109] op_sel:[1,1,0] op_sel_hi:[1,0,1] neg_lo:[0,1,0]
    v_cvt_pk_bf16_f32 v111, v104, v105
    v_pk_mul_f32 v[96:97], v[94:95], v[82:83] op_sel:[0,0] op_sel_hi:[0,1] neg_hi:[0,1]
    ds_write_b32 v24, v111 offset:7888
    v_pk_fma_f32 v[92:93], v[94:95], v[82:83], v[96:97] op_sel:[1,1,0] op_sel_hi:[1,0,1]
    v_pk_mul_f32 v[108:109], v[104:105], v[84:85] op_sel:[0,0] op_sel_hi:[0,1]
    v_pk_fma_f32 v[106:107], v[104:105], v[84:85], v[108:109] op_sel:[1,1,0] op_sel_hi:[1,0,1] neg_lo:[0,1,0]
    v_cvt_pk_bf16_f32 v101, v92, v93
    v_cvt_pk_bf16_f32 v110, v106, v107
    ds_write_b32 v24, v101 offset:1360
    ds_write_b32 v24, v110 offset:8160
    v_pk_mul_f32 v[108:109], v[106:107], v[84:85] op_sel:[0,0] op_sel_hi:[0,1]
    v_pk_mul_f32 v[96:97], v[92:93], v[82:83] op_sel:[0,0] op_sel_hi:[0,1] neg_hi:[0,1]
    v_pk_fma_f32 v[104:105], v[106:107], v[84:85], v[108:109] op_sel:[1,1,0] op_sel_hi:[1,0,1] neg_lo:[0,1,0]
    v_pk_fma_f32 v[94:95], v[92:93], v[82:83], v[96:97] op_sel:[1,1,0] op_sel_hi:[1,0,1]
    v_cvt_pk_bf16_f32 v111, v104, v105
    ds_write_b32 v24, v111 offset:8432
    v_cvt_pk_bf16_f32 v102, v94, v95
    v_pk_mul_f32 v[108:109], v[104:105], v[84:85] op_sel:[0,0] op_sel_hi:[0,1]
    ds_write_b32 v24, v102 offset:1632
    v_pk_fma_f32 v[106:107], v[104:105], v[84:85], v[108:109] op_sel:[1,1,0] op_sel_hi:[1,0,1] neg_lo:[0,1,0]
    v_cvt_pk_bf16_f32 v110, v106, v107
    v_pk_mul_f32 v[96:97], v[94:95], v[82:83] op_sel:[0,0] op_sel_hi:[0,1] neg_hi:[0,1]
    ds_write_b32 v24, v110 offset:8704
    v_pk_fma_f32 v[92:93], v[94:95], v[82:83], v[96:97] op_sel:[1,1,0] op_sel_hi:[1,0,1]
    v_pk_mul_f32 v[108:109], v[106:107], v[84:85] op_sel:[0,0] op_sel_hi:[0,1]
    v_pk_fma_f32 v[104:105], v[106:107], v[84:85], v[108:109] op_sel:[1,1,0] op_sel_hi:[1,0,1] neg_lo:[0,1,0]
    v_cvt_pk_bf16_f32 v103, v92, v93
    v_cvt_pk_bf16_f32 v111, v104, v105
    ds_write_b32 v24, v103 offset:1904
    ds_write_b32 v24, v111 offset:8976
    v_pk_mul_f32 v[108:109], v[104:105], v[84:85] op_sel:[0,0] op_sel_hi:[0,1]
    v_pk_mul_f32 v[96:97], v[98:99], v[86:87] op_sel:[0,0] op_sel_hi:[0,1] neg_hi:[0,1]
    v_pk_fma_f32 v[106:107], v[104:105], v[84:85], v[108:109] op_sel:[1,1,0] op_sel_hi:[1,0,1] neg_lo:[0,1,0]
    v_pk_fma_f32 v[112:113], v[98:99], v[86:87], v[96:97] op_sel:[1,1,0] op_sel_hi:[1,0,1]
    v_cvt_pk_bf16_f32 v110, v106, v107
    ds_write_b32 v24, v110 offset:9248
    v_cvt_pk_bf16_f32 v100, v112, v113
    v_pk_mul_f32 v[108:109], v[106:107], v[84:85] op_sel:[0,0] op_sel_hi:[0,1]
    ds_write_b32 v24, v100 offset:2176
    v_pk_fma_f32 v[104:105], v[106:107], v[84:85], v[108:109] op_sel:[1,1,0] op_sel_hi:[1,0,1] neg_lo:[0,1,0]
    v_cvt_pk_bf16_f32 v111, v104, v105
    v_pk_mul_f32 v[96:97], v[112:113], v[88:89] op_sel:[0,0] op_sel_hi:[0,1] neg_hi:[0,1]
    ds_write_b32 v24, v111 offset:9520
    v_pk_fma_f32 v[92:93], v[112:113], v[88:89], v[96:97] op_sel:[1,1,0] op_sel_hi:[1,0,1]
    v_pk_mul_f32 v[108:109], v[104:105], v[84:85] op_sel:[0,0] op_sel_hi:[0,1]
    v_pk_fma_f32 v[106:107], v[104:105], v[84:85], v[108:109] op_sel:[1,1,0] op_sel_hi:[1,0,1] neg_lo:[0,1,0]
    v_cvt_pk_bf16_f32 v101, v92, v93
    v_cvt_pk_bf16_f32 v110, v106, v107
    ds_write_b32 v24, v101 offset:2448
    ds_write_b32 v24, v110 offset:9792
    v_pk_mul_f32 v[108:109], v[106:107], v[84:85] op_sel:[0,0] op_sel_hi:[0,1]
    v_pk_mul_f32 v[96:97], v[92:93], v[88:89] op_sel:[0,0] op_sel_hi:[0,1] neg_hi:[0,1]
    v_pk_fma_f32 v[104:105], v[106:107], v[84:85], v[108:109] op_sel:[1,1,0] op_sel_hi:[1,0,1] neg_lo:[0,1,0]
    v_pk_fma_f32 v[94:95], v[92:93], v[88:89], v[96:97] op_sel:[1,1,0] op_sel_hi:[1,0,1]
    v_cvt_pk_bf16_f32 v111, v104, v105
    v_cvt_pk_bf16_f32 v102, v94, v95
    ds_write_b32 v24, v111 offset:10064
    v_pk_mul_f32 v[108:109], v[104:105], v[84:85] op_sel:[0,0] op_sel_hi:[0,1]
    ds_write_b32 v24, v102 offset:2720
    v_pk_fma_f32 v[106:107], v[104:105], v[84:85], v[108:109] op_sel:[1,1,0] op_sel_hi:[1,0,1] neg_lo:[0,1,0]
    v_pk_mul_f32 v[96:97], v[94:95], v[88:89] op_sel:[0,0] op_sel_hi:[0,1] neg_hi:[0,1]
    v_cvt_pk_bf16_f32 v110, v106, v107
    ds_write_b32 v24, v110 offset:10336
    v_pk_fma_f32 v[92:93], v[94:95], v[88:89], v[96:97] op_sel:[1,1,0] op_sel_hi:[1,0,1]
    v_pk_mul_f32 v[108:109], v[106:107], v[84:85] op_sel:[0,0] op_sel_hi:[0,1]
    v_cvt_pk_bf16_f32 v103, v92, v93
    v_pk_fma_f32 v[104:105], v[106:107], v[84:85], v[108:109] op_sel:[1,1,0] op_sel_hi:[1,0,1] neg_lo:[0,1,0]
    v_cvt_pk_bf16_f32 v111, v104, v105
    ds_write_b32 v24, v103 offset:2992
    ds_write_b32 v24, v111 offset:10608
    v_pk_mul_f32 v[96:97], v[112:113], v[86:87] op_sel:[0,0] op_sel_hi:[0,1] neg_hi:[0,1]
    v_pk_mul_f32 v[108:109], v[104:105], v[84:85] op_sel:[0,0] op_sel_hi:[0,1]
    v_pk_fma_f32 v[106:107], v[104:105], v[84:85], v[108:109] op_sel:[1,1,0] op_sel_hi:[1,0,1] neg_lo:[0,1,0]
    v_pk_fma_f32 v[112:113], v[112:113], v[86:87], v[96:97] op_sel:[1,1,0] op_sel_hi:[1,0,1]
    v_cvt_pk_bf16_f32 v110, v106, v107
    v_cvt_pk_bf16_f32 v100, v112, v113
    ds_write_b32 v24, v110 offset:10880
    v_pk_mul_f32 v[108:109], v[106:107], v[84:85] op_sel:[0,0] op_sel_hi:[0,1]
    ds_write_b32 v24, v100 offset:3264
    v_pk_fma_f32 v[104:105], v[106:107], v[84:85], v[108:109] op_sel:[1,1,0] op_sel_hi:[1,0,1] neg_lo:[0,1,0]
    v_pk_mul_f32 v[96:97], v[112:113], v[90:91] op_sel:[0,0] op_sel_hi:[0,1] neg_hi:[0,1]
    v_cvt_pk_bf16_f32 v111, v104, v105
    ds_write_b32 v24, v111 offset:11152
    v_pk_fma_f32 v[92:93], v[112:113], v[90:91], v[96:97] op_sel:[1,1,0] op_sel_hi:[1,0,1]
    v_pk_mul_f32 v[108:109], v[104:105], v[84:85] op_sel:[0,0] op_sel_hi:[0,1]
    v_cvt_pk_bf16_f32 v101, v92, v93
    v_pk_fma_f32 v[106:107], v[104:105], v[84:85], v[108:109] op_sel:[1,1,0] op_sel_hi:[1,0,1] neg_lo:[0,1,0]
    v_cvt_pk_bf16_f32 v110, v106, v107
    ds_write_b32 v24, v101 offset:3536
    ds_write_b32 v24, v110 offset:11424
    v_pk_mul_f32 v[96:97], v[112:113], v[86:87] op_sel:[0,0] op_sel_hi:[0,1] neg_hi:[0,1]
    v_pk_mul_f32 v[108:109], v[106:107], v[84:85] op_sel:[0,0] op_sel_hi:[0,1]
    v_pk_fma_f32 v[104:105], v[106:107], v[84:85], v[108:109] op_sel:[1,1,0] op_sel_hi:[1,0,1] neg_lo:[0,1,0]
    v_pk_fma_f32 v[112:113], v[112:113], v[86:87], v[96:97] op_sel:[1,1,0] op_sel_hi:[1,0,1]
    v_cvt_pk_bf16_f32 v111, v104, v105
    v_cvt_pk_bf16_f32 v102, v112, v113
    ds_write_b32 v24, v111 offset:11696
    v_pk_mul_f32 v[108:109], v[104:105], v[84:85] op_sel:[0,0] op_sel_hi:[0,1]
    ds_write_b32 v24, v102 offset:3808
    v_pk_fma_f32 v[106:107], v[104:105], v[84:85], v[108:109] op_sel:[1,1,0] op_sel_hi:[1,0,1] neg_lo:[0,1,0]
    v_pk_mul_f32 v[96:97], v[112:113], v[90:91] op_sel:[0,0] op_sel_hi:[0,1] neg_hi:[0,1]
    v_cvt_pk_bf16_f32 v110, v106, v107
    ds_write_b32 v24, v110 offset:11968
    v_pk_fma_f32 v[92:93], v[112:113], v[90:91], v[96:97] op_sel:[1,1,0] op_sel_hi:[1,0,1]
    v_pk_mul_f32 v[108:109], v[106:107], v[84:85] op_sel:[0,0] op_sel_hi:[0,1]
    v_cvt_pk_bf16_f32 v103, v92, v93
    v_pk_fma_f32 v[104:105], v[106:107], v[84:85], v[108:109] op_sel:[1,1,0] op_sel_hi:[1,0,1] neg_lo:[0,1,0]
    v_cvt_pk_bf16_f32 v111, v104, v105
    ds_write_b32 v24, v103 offset:4080
    ds_write_b32 v24, v111 offset:12240
    v_pk_mul_f32 v[96:97], v[112:113], v[86:87] op_sel:[0,0] op_sel_hi:[0,1] neg_hi:[0,1]
    v_pk_mul_f32 v[108:109], v[104:105], v[84:85] op_sel:[0,0] op_sel_hi:[0,1]
    v_pk_fma_f32 v[106:107], v[104:105], v[84:85], v[108:109] op_sel:[1,1,0] op_sel_hi:[1,0,1] neg_lo:[0,1,0]
    v_pk_fma_f32 v[112:113], v[112:113], v[86:87], v[96:97] op_sel:[1,1,0] op_sel_hi:[1,0,1]
    v_cvt_pk_bf16_f32 v110, v106, v107
    v_cvt_pk_bf16_f32 v100, v112, v113
    ds_write_b32 v24, v110 offset:12512
    v_pk_mul_f32 v[108:109], v[106:107], v[84:85] op_sel:[0,0] op_sel_hi:[0,1]
    ds_write_b32 v24, v100 offset:4352
    v_pk_fma_f32 v[104:105], v[106:107], v[84:85], v[108:109] op_sel:[1,1,0] op_sel_hi:[1,0,1] neg_lo:[0,1,0]
    v_pk_mul_f32 v[96:97], v[112:113], v[86:87] op_sel:[0,0] op_sel_hi:[0,1] neg_hi:[0,1]
    v_cvt_pk_bf16_f32 v111, v104, v105
    ds_write_b32 v24, v111 offset:12784
    v_pk_fma_f32 v[112:113], v[112:113], v[86:87], v[96:97] op_sel:[1,1,0] op_sel_hi:[1,0,1]
    v_pk_mul_f32 v[108:109], v[104:105], v[84:85] op_sel:[0,0] op_sel_hi:[0,1]
    v_cvt_pk_bf16_f32 v101, v112, v113
    v_pk_fma_f32 v[106:107], v[104:105], v[84:85], v[108:109] op_sel:[1,1,0] op_sel_hi:[1,0,1] neg_lo:[0,1,0]
    v_cvt_pk_bf16_f32 v110, v106, v107
    ds_write_b32 v24, v101 offset:4624
    ds_write_b32 v24, v110 offset:13056
    v_pk_mul_f32 v[96:97], v[112:113], v[86:87] op_sel:[0,0] op_sel_hi:[0,1] neg_hi:[0,1]
    v_pk_mul_f32 v[108:109], v[106:107], v[84:85] op_sel:[0,0] op_sel_hi:[0,1]
    v_pk_fma_f32 v[104:105], v[106:107], v[84:85], v[108:109] op_sel:[1,1,0] op_sel_hi:[1,0,1] neg_lo:[0,1,0]
    v_pk_fma_f32 v[112:113], v[112:113], v[86:87], v[96:97] op_sel:[1,1,0] op_sel_hi:[1,0,1]
    v_cvt_pk_bf16_f32 v111, v104, v105
    v_cvt_pk_bf16_f32 v102, v112, v113
    ds_write_b32 v24, v111 offset:13328
    v_pk_mul_f32 v[108:109], v[104:105], v[84:85] op_sel:[0,0] op_sel_hi:[0,1]
    ds_write_b32 v24, v102 offset:4896
    v_pk_fma_f32 v[106:107], v[104:105], v[84:85], v[108:109] op_sel:[1,1,0] op_sel_hi:[1,0,1] neg_lo:[0,1,0]
    v_pk_mul_f32 v[96:97], v[112:113], v[86:87] op_sel:[0,0] op_sel_hi:[0,1] neg_hi:[0,1]
    v_cvt_pk_bf16_f32 v110, v106, v107
    ds_write_b32 v24, v110 offset:13600
    v_pk_fma_f32 v[112:113], v[112:113], v[86:87], v[96:97] op_sel:[1,1,0] op_sel_hi:[1,0,1]
    v_pk_mul_f32 v[108:109], v[106:107], v[84:85] op_sel:[0,0] op_sel_hi:[0,1]
    v_cvt_pk_bf16_f32 v103, v112, v113
    v_pk_fma_f32 v[104:105], v[106:107], v[84:85], v[108:109] op_sel:[1,1,0] op_sel_hi:[1,0,1] neg_lo:[0,1,0]
    v_cvt_pk_bf16_f32 v111, v104, v105
    ds_write_b32 v24, v103 offset:5168
    ds_write_b32 v24, v111 offset:13872
    v_pk_mul_f32 v[96:97], v[112:113], v[86:87] op_sel:[0,0] op_sel_hi:[0,1] neg_hi:[0,1]
    v_pk_mul_f32 v[108:109], v[104:105], v[84:85] op_sel:[0,0] op_sel_hi:[0,1]
    v_pk_fma_f32 v[106:107], v[104:105], v[84:85], v[108:109] op_sel:[1,1,0] op_sel_hi:[1,0,1] neg_lo:[0,1,0]
    v_pk_fma_f32 v[112:113], v[112:113], v[86:87], v[96:97] op_sel:[1,1,0] op_sel_hi:[1,0,1]
    v_cvt_pk_bf16_f32 v110, v106, v107
    v_cvt_pk_bf16_f32 v100, v112, v113
    ds_write_b32 v24, v110 offset:14144
    ds_write_b32 v24, v100 offset:5440
    s_waitcnt lgkmcnt(0)
    ds_read_b128 v[128:131], v25 offset:0
    ds_read_b128 v[132:135], v25 offset:5712
    ds_read_b128 v[136:139], v25 offset:32
    ds_read_b128 v[140:143], v25 offset:5744
    ds_read_b128 v[144:147], v25 offset:64
    ds_read_b128 v[148:151], v25 offset:5776
    ds_read_b128 v[152:155], v25 offset:96
    ds_read_b128 v[156:159], v25 offset:5808
    ds_read_b128 v[160:163], v25 offset:128
    ds_read_b128 v[164:167], v25 offset:5840
    ds_read_b128 v[168:171], v25 offset:160
    ds_read_b128 v[172:175], v25 offset:5872
    ds_read_b128 v[176:179], v25 offset:192
    ds_read_b128 v[180:183], v25 offset:5904
    s_waitcnt lgkmcnt(12)
    v_mfma_f32_32x32x16_bf16 v[64:79], v[128:131], v[132:135], 0
    ds_read_b128 v[184:187], v25 offset:224
    ds_read_b128 v[188:191], v25 offset:5936
    v_lshlrev_b32 v11, 16, v11
    v_lshlrev_b32 v14, 16, v14
    v_mul_f32 v11, 0x3fb8aa3b, v11
    v_lshlrev_b32 v17, 16, v17
    v_exp_f32 v11, v11
    s_waitcnt lgkmcnt(12)
    v_mfma_f32_32x32x16_bf16 v[64:79], v[136:139], v[140:143], v[64:79]
    v_lshlrev_b32 v20, 16, v20
    v_mul_f32 v81, v14, v31
    v_cvt_pk_bf16_f32 v11, v11, v11
    v_mul_f32 v98, v17, v9
    v_lshlrev_b32 v11, 16, v11
    v_mul_f32 v99, v20, v9
    s_waitcnt lgkmcnt(10)
    v_mfma_f32_32x32x16_bf16 v[64:79], v[144:147], v[148:151], v[64:79]
    v_mul_f32 v80, v11, v30
    v_sub_f32 v99, 0, v99
    v_sub_f32 v80, 0, v80
    v_mul_f32 v114, 0x3f800000, v80
    v_mul_f32 v117, 0x3f800000, v81
    s_waitcnt lgkmcnt(8)
    v_mfma_f32_32x32x16_bf16 v[64:79], v[152:155], v[156:159], v[64:79]
    v_mul_f32 v115, 0x41000000, v80
    v_mul_f32 v118, 0x41000000, v81
    v_mul_f32 v116, 0x43800000, v80
    v_mul_f32 v119, 0x43800000, v81
    v_exp_f32 v114, v114
    v_fract_f32 v117, v117
    s_waitcnt lgkmcnt(6)
    v_mfma_f32_32x32x16_bf16 v[64:79], v[160:163], v[164:167], v[64:79]
    v_exp_f32 v115, v115
    v_fract_f32 v118, v118
    v_exp_f32 v116, v116
    v_fract_f32 v119, v119
    v_cos_f32 v82, v117
    s_waitcnt lgkmcnt(4)
    v_mfma_f32_32x32x16_bf16 v[64:79], v[168:171], v[172:175], v[64:79]
    v_sin_f32 v83, v117
    v_cos_f32 v84, v118
    v_sin_f32 v85, v118
    v_cos_f32 v86, v119
    v_sin_f32 v87, v119
    s_nop 0
    s_waitcnt lgkmcnt(2)
    v_mfma_f32_32x32x16_bf16 v[64:79], v[176:179], v[180:183], v[64:79]
    v_mul_f32 v82, v82, v114
    v_mul_f32 v83, v83, v114
    v_mul_f32 v84, v84, v115
    v_mul_f32 v85, v85, v115
    v_mul_f32 v86, v86, v116
    s_waitcnt lgkmcnt(0)
    v_mfma_f32_32x32x16_bf16 v[64:79], v[184:187], v[188:191], v[64:79]
    v_mul_f32 v87, v87, v116
    v_pk_mul_f32 v[96:97], v[82:83], v[82:83] op_sel:[0,0] op_sel_hi:[0,1]
    v_pk_fma_f32 v[88:89], v[82:83], v[82:83], v[96:97] op_sel:[1,1,0] op_sel_hi:[1,0,1] neg_lo:[0,1,0]
    s_nop 0
    v_pk_mul_f32 v[96:97], v[88:89], v[88:89] op_sel:[0,0] op_sel_hi:[0,1]
    v_pk_fma_f32 v[90:91], v[88:89], v[88:89], v[96:97] op_sel:[1,1,0] op_sel_hi:[1,0,1] neg_lo:[0,1,0]
    v_cvt_pk_bf16_f32 v110, v84, v85
    ds_write_b32 v24, v110 offset:5984
    v_cvt_pk_bf16_f32 v100, v98, v99
    v_pk_mul_f32 v[108:109], v[84:85], v[84:85] op_sel:[0,0] op_sel_hi:[0,1]
    ds_write_b32 v24, v100 offset:0
    v_pk_fma_f32 v[104:105], v[84:85], v[84:85], v[108:109] op_sel:[1,1,0] op_sel_hi:[1,0,1] neg_lo:[0,1,0]
    v_cvt_pk_bf16_f32 v111, v104, v105
    v_pk_mul_f32 v[96:97], v[98:99], v[82:83] op_sel:[0,0] op_sel_hi:[0,1] neg_hi:[0,1]
    ds_write_b32 v24, v111 offset:6256
    v_pk_fma_f32 v[92:93], v[98:99], v[82:83], v[96:97] op_sel:[1,1,0] op_sel_hi:[1,0,1]
    v_pk_mul_f32 v[108:109], v[104:105], v[84:85] op_sel:[0,0] op_sel_hi:[0,1]
    v_pk_fma_f32 v[106:107], v[104:105], v[84:85], v[108:109] op_sel:[1,1,0] op_sel_hi:[1,0,1] neg_lo:[0,1,0]
    v_cvt_pk_bf16_f32 v101, v92, v93
    v_cvt_pk_bf16_f32 v110, v106, v107
    ds_write_b32 v24, v101 offset:272
    ds_write_b32 v24, v110 offset:6528
    v_pk_mul_f32 v[108:109], v[106:107], v[84:85] op_sel:[0,0] op_sel_hi:[0,1]
    v_pk_mul_f32 v[96:97], v[92:93], v[82:83] op_sel:[0,0] op_sel_hi:[0,1] neg_hi:[0,1]
    v_pk_fma_f32 v[104:105], v[106:107], v[84:85], v[108:109] op_sel:[1,1,0] op_sel_hi:[1,0,1] neg_lo:[0,1,0]
    v_pk_fma_f32 v[94:95], v[92:93], v[82:83], v[96:97] op_sel:[1,1,0] op_sel_hi:[1,0,1]
    v_cvt_pk_bf16_f32 v111, v104, v105
    ds_write_b32 v24, v111 offset:6800
    v_cvt_pk_bf16_f32 v102, v94, v95
    v_pk_mul_f32 v[108:109], v[104:105], v[84:85] op_sel:[0,0] op_sel_hi:[0,1]
    ds_write_b32 v24, v102 offset:544
    v_pk_fma_f32 v[106:107], v[104:105], v[84:85], v[108:109] op_sel:[1,1,0] op_sel_hi:[1,0,1] neg_lo:[0,1,0]
    v_cvt_pk_bf16_f32 v110, v106, v107
    v_pk_mul_f32 v[96:97], v[94:95], v[82:83] op_sel:[0,0] op_sel_hi:[0,1] neg_hi:[0,1]
    ds_write_b32 v24, v110 offset:7072
    v_pk_fma_f32 v[92:93], v[94:95], v[82:83], v[96:97] op_sel:[1,1,0] op_sel_hi:[1,0,1]
    v_pk_mul_f32 v[108:109], v[106:107], v[84:85] op_sel:[0,0] op_sel_hi:[0,1]
    v_pk_fma_f32 v[104:105], v[106:107], v[84:85], v[108:109] op_sel:[1,1,0] op_sel_hi:[1,0,1] neg_lo:[0,1,0]
    v_cvt_pk_bf16_f32 v103, v92, v93
    v_cvt_pk_bf16_f32 v111, v104, v105
    ds_write_b32 v24, v103 offset:816
    ds_write_b32 v24, v111 offset:7344
    v_pk_mul_f32 v[108:109], v[104:105], v[84:85] op_sel:[0,0] op_sel_hi:[0,1]
    v_pk_mul_f32 v[96:97], v[92:93], v[82:83] op_sel:[0,0] op_sel_hi:[0,1] neg_hi:[0,1]
    v_pk_fma_f32 v[106:107], v[104:105], v[84:85], v[108:109] op_sel:[1,1,0] op_sel_hi:[1,0,1] neg_lo:[0,1,0]
    v_pk_fma_f32 v[94:95], v[92:93], v[82:83], v[96:97] op_sel:[1,1,0] op_sel_hi:[1,0,1]
    v_cvt_pk_bf16_f32 v110, v106, v107
    ds_write_b32 v24, v110 offset:7616
    v_cvt_pk_bf16_f32 v100, v94, v95
    v_pk_mul_f32 v[108:109], v[106:107], v[84:85] op_sel:[0,0] op_sel_hi:[0,1]
    ds_write_b32 v24, v100 offset:1088
    v_pk_fma_f32 v[104:105], v[106:107], v[84:85], v[108:109] op_sel:[1,1,0] op_sel_hi:[1,0,1] neg_lo:[0,1,0]
    v_cvt_pk_bf16_f32 v111, v104, v105
    v_pk_mul_f32 v[96:97], v[94:95], v[82:83] op_sel:[0,0] op_sel_hi:[0,1] neg_hi:[0,1]
    ds_write_b32 v24, v111 offset:7888
    v_pk_fma_f32 v[92:93], v[94:95], v[82:83], v[96:97] op_sel:[1,1,0] op_sel_hi:[1,0,1]
    v_pk_mul_f32 v[108:109], v[104:105], v[84:85] op_sel:[0,0] op_sel_hi:[0,1]
    v_pk_fma_f32 v[106:107], v[104:105], v[84:85], v[108:109] op_sel:[1,1,0] op_sel_hi:[1,0,1] neg_lo:[0,1,0]
    v_cvt_pk_bf16_f32 v101, v92, v93
    v_cvt_pk_bf16_f32 v110, v106, v107
    ds_write_b32 v24, v101 offset:1360
    ds_write_b32 v24, v110 offset:8160
    v_pk_mul_f32 v[108:109], v[106:107], v[84:85] op_sel:[0,0] op_sel_hi:[0,1]
    v_pk_mul_f32 v[96:97], v[92:93], v[82:83] op_sel:[0,0] op_sel_hi:[0,1] neg_hi:[0,1]
    v_pk_fma_f32 v[104:105], v[106:107], v[84:85], v[108:109] op_sel:[1,1,0] op_sel_hi:[1,0,1] neg_lo:[0,1,0]
    v_pk_fma_f32 v[94:95], v[92:93], v[82:83], v[96:97] op_sel:[1,1,0] op_sel_hi:[1,0,1]
    v_cvt_pk_bf16_f32 v111, v104, v105
    ds_write_b32 v24, v111 offset:8432
    v_cvt_pk_bf16_f32 v102, v94, v95
    v_pk_mul_f32 v[108:109], v[104:105], v[84:85] op_sel:[0,0] op_sel_hi:[0,1]
    ds_write_b32 v24, v102 offset:1632
    v_pk_fma_f32 v[106:107], v[104:105], v[84:85], v[108:109] op_sel:[1,1,0] op_sel_hi:[1,0,1] neg_lo:[0,1,0]
    v_cvt_pk_bf16_f32 v110, v106, v107
    v_pk_mul_f32 v[96:97], v[94:95], v[82:83] op_sel:[0,0] op_sel_hi:[0,1] neg_hi:[0,1]
    ds_write_b32 v24, v110 offset:8704
    v_pk_fma_f32 v[92:93], v[94:95], v[82:83], v[96:97] op_sel:[1,1,0] op_sel_hi:[1,0,1]
    v_pk_mul_f32 v[108:109], v[106:107], v[84:85] op_sel:[0,0] op_sel_hi:[0,1]
    v_pk_fma_f32 v[104:105], v[106:107], v[84:85], v[108:109] op_sel:[1,1,0] op_sel_hi:[1,0,1] neg_lo:[0,1,0]
    v_cvt_pk_bf16_f32 v103, v92, v93
    v_cvt_pk_bf16_f32 v111, v104, v105
    ds_write_b32 v24, v103 offset:1904
    ds_write_b32 v24, v111 offset:8976
    v_pk_mul_f32 v[108:109], v[104:105], v[84:85] op_sel:[0,0] op_sel_hi:[0,1]
    v_pk_mul_f32 v[96:97], v[98:99], v[86:87] op_sel:[0,0] op_sel_hi:[0,1] neg_hi:[0,1]
    v_pk_fma_f32 v[106:107], v[104:105], v[84:85], v[108:109] op_sel:[1,1,0] op_sel_hi:[1,0,1] neg_lo:[0,1,0]
    v_pk_fma_f32 v[112:113], v[98:99], v[86:87], v[96:97] op_sel:[1,1,0] op_sel_hi:[1,0,1]
    v_cvt_pk_bf16_f32 v110, v106, v107
    ds_write_b32 v24, v110 offset:9248
    v_cvt_pk_bf16_f32 v100, v112, v113
    v_pk_mul_f32 v[108:109], v[106:107], v[84:85] op_sel:[0,0] op_sel_hi:[0,1]
    ds_write_b32 v24, v100 offset:2176
    v_pk_fma_f32 v[104:105], v[106:107], v[84:85], v[108:109] op_sel:[1,1,0] op_sel_hi:[1,0,1] neg_lo:[0,1,0]
    v_cvt_pk_bf16_f32 v111, v104, v105
    v_pk_mul_f32 v[96:97], v[112:113], v[88:89] op_sel:[0,0] op_sel_hi:[0,1] neg_hi:[0,1]
    ds_write_b32 v24, v111 offset:9520
    v_pk_fma_f32 v[92:93], v[112:113], v[88:89], v[96:97] op_sel:[1,1,0] op_sel_hi:[1,0,1]
    v_pk_mul_f32 v[108:109], v[104:105], v[84:85] op_sel:[0,0] op_sel_hi:[0,1]
    v_pk_fma_f32 v[106:107], v[104:105], v[84:85], v[108:109] op_sel:[1,1,0] op_sel_hi:[1,0,1] neg_lo:[0,1,0]
    v_cvt_pk_bf16_f32 v101, v92, v93
    v_cvt_pk_bf16_f32 v110, v106, v107
    ds_write_b32 v24, v101 offset:2448
    ds_write_b32 v24, v110 offset:9792
    v_pk_mul_f32 v[108:109], v[106:107], v[84:85] op_sel:[0,0] op_sel_hi:[0,1]
    v_pk_mul_f32 v[96:97], v[92:93], v[88:89] op_sel:[0,0] op_sel_hi:[0,1] neg_hi:[0,1]
    v_pk_fma_f32 v[104:105], v[106:107], v[84:85], v[108:109] op_sel:[1,1,0] op_sel_hi:[1,0,1] neg_lo:[0,1,0]
    v_pk_fma_f32 v[94:95], v[92:93], v[88:89], v[96:97] op_sel:[1,1,0] op_sel_hi:[1,0,1]
    v_cvt_pk_bf16_f32 v111, v104, v105
    v_cvt_pk_bf16_f32 v102, v94, v95
    ds_write_b32 v24, v111 offset:10064
    v_pk_mul_f32 v[108:109], v[104:105], v[84:85] op_sel:[0,0] op_sel_hi:[0,1]
    ds_write_b32 v24, v102 offset:2720
    v_pk_fma_f32 v[106:107], v[104:105], v[84:85], v[108:109] op_sel:[1,1,0] op_sel_hi:[1,0,1] neg_lo:[0,1,0]
    v_pk_mul_f32 v[96:97], v[94:95], v[88:89] op_sel:[0,0] op_sel_hi:[0,1] neg_hi:[0,1]
    v_cvt_pk_bf16_f32 v110, v106, v107
    ds_write_b32 v24, v110 offset:10336
    v_pk_fma_f32 v[92:93], v[94:95], v[88:89], v[96:97] op_sel:[1,1,0] op_sel_hi:[1,0,1]
    v_pk_mul_f32 v[108:109], v[106:107], v[84:85] op_sel:[0,0] op_sel_hi:[0,1]
    v_cvt_pk_bf16_f32 v103, v92, v93
    v_pk_fma_f32 v[104:105], v[106:107], v[84:85], v[108:109] op_sel:[1,1,0] op_sel_hi:[1,0,1] neg_lo:[0,1,0]
    v_cvt_pk_bf16_f32 v111, v104, v105
    ds_write_b32 v24, v103 offset:2992
    ds_write_b32 v24, v111 offset:10608
    v_pk_mul_f32 v[96:97], v[112:113], v[86:87] op_sel:[0,0] op_sel_hi:[0,1] neg_hi:[0,1]
    v_pk_mul_f32 v[108:109], v[104:105], v[84:85] op_sel:[0,0] op_sel_hi:[0,1]
    v_pk_fma_f32 v[106:107], v[104:105], v[84:85], v[108:109] op_sel:[1,1,0] op_sel_hi:[1,0,1] neg_lo:[0,1,0]
    v_pk_fma_f32 v[112:113], v[112:113], v[86:87], v[96:97] op_sel:[1,1,0] op_sel_hi:[1,0,1]
    v_cvt_pk_bf16_f32 v110, v106, v107
    v_cvt_pk_bf16_f32 v100, v112, v113
    ds_write_b32 v24, v110 offset:10880
    v_pk_mul_f32 v[108:109], v[106:107], v[84:85] op_sel:[0,0] op_sel_hi:[0,1]
    ds_write_b32 v24, v100 offset:3264
    v_pk_fma_f32 v[104:105], v[106:107], v[84:85], v[108:109] op_sel:[1,1,0] op_sel_hi:[1,0,1] neg_lo:[0,1,0]
    v_pk_mul_f32 v[96:97], v[112:113], v[90:91] op_sel:[0,0] op_sel_hi:[0,1] neg_hi:[0,1]
    v_cvt_pk_bf16_f32 v111, v104, v105
    ds_write_b32 v24, v111 offset:11152
    v_pk_fma_f32 v[92:93], v[112:113], v[90:91], v[96:97] op_sel:[1,1,0] op_sel_hi:[1,0,1]
    v_pk_mul_f32 v[108:109], v[104:105], v[84:85] op_sel:[0,0] op_sel_hi:[0,1]
    v_cvt_pk_bf16_f32 v101, v92, v93
    v_pk_fma_f32 v[106:107], v[104:105], v[84:85], v[108:109] op_sel:[1,1,0] op_sel_hi:[1,0,1] neg_lo:[0,1,0]
    v_cvt_pk_bf16_f32 v110, v106, v107
    ds_write_b32 v24, v101 offset:3536
    ds_write_b32 v24, v110 offset:11424
    v_pk_mul_f32 v[96:97], v[112:113], v[86:87] op_sel:[0,0] op_sel_hi:[0,1] neg_hi:[0,1]
    v_pk_mul_f32 v[108:109], v[106:107], v[84:85] op_sel:[0,0] op_sel_hi:[0,1]
    v_pk_fma_f32 v[104:105], v[106:107], v[84:85], v[108:109] op_sel:[1,1,0] op_sel_hi:[1,0,1] neg_lo:[0,1,0]
    v_pk_fma_f32 v[112:113], v[112:113], v[86:87], v[96:97] op_sel:[1,1,0] op_sel_hi:[1,0,1]
    v_cvt_pk_bf16_f32 v111, v104, v105
    v_cvt_pk_bf16_f32 v102, v112, v113
    ds_write_b32 v24, v111 offset:11696
    v_pk_mul_f32 v[108:109], v[104:105], v[84:85] op_sel:[0,0] op_sel_hi:[0,1]
    ds_write_b32 v24, v102 offset:3808
    v_pk_fma_f32 v[106:107], v[104:105], v[84:85], v[108:109] op_sel:[1,1,0] op_sel_hi:[1,0,1] neg_lo:[0,1,0]
    v_pk_mul_f32 v[96:97], v[112:113], v[90:91] op_sel:[0,0] op_sel_hi:[0,1] neg_hi:[0,1]
    v_cvt_pk_bf16_f32 v110, v106, v107
    ds_write_b32 v24, v110 offset:11968
    v_pk_fma_f32 v[92:93], v[112:113], v[90:91], v[96:97] op_sel:[1,1,0] op_sel_hi:[1,0,1]
    v_pk_mul_f32 v[108:109], v[106:107], v[84:85] op_sel:[0,0] op_sel_hi:[0,1]
    v_cvt_pk_bf16_f32 v103, v92, v93
    v_pk_fma_f32 v[104:105], v[106:107], v[84:85], v[108:109] op_sel:[1,1,0] op_sel_hi:[1,0,1] neg_lo:[0,1,0]
    v_cvt_pk_bf16_f32 v111, v104, v105
    ds_write_b32 v24, v103 offset:4080
    ds_write_b32 v24, v111 offset:12240
    v_pk_mul_f32 v[96:97], v[112:113], v[86:87] op_sel:[0,0] op_sel_hi:[0,1] neg_hi:[0,1]
    v_pk_mul_f32 v[108:109], v[104:105], v[84:85] op_sel:[0,0] op_sel_hi:[0,1]
    v_pk_fma_f32 v[106:107], v[104:105], v[84:85], v[108:109] op_sel:[1,1,0] op_sel_hi:[1,0,1] neg_lo:[0,1,0]
    v_pk_fma_f32 v[112:113], v[112:113], v[86:87], v[96:97] op_sel:[1,1,0] op_sel_hi:[1,0,1]
    v_cvt_pk_bf16_f32 v110, v106, v107
    v_cvt_pk_bf16_f32 v100, v112, v113
    ds_write_b32 v24, v110 offset:12512
    v_pk_mul_f32 v[108:109], v[106:107], v[84:85] op_sel:[0,0] op_sel_hi:[0,1]
    ds_write_b32 v24, v100 offset:4352
    v_pk_fma_f32 v[104:105], v[106:107], v[84:85], v[108:109] op_sel:[1,1,0] op_sel_hi:[1,0,1] neg_lo:[0,1,0]
    v_pk_mul_f32 v[96:97], v[112:113], v[86:87] op_sel:[0,0] op_sel_hi:[0,1] neg_hi:[0,1]
    v_cvt_pk_bf16_f32 v111, v104, v105
    ds_write_b32 v24, v111 offset:12784
    v_pk_fma_f32 v[112:113], v[112:113], v[86:87], v[96:97] op_sel:[1,1,0] op_sel_hi:[1,0,1]
    v_pk_mul_f32 v[108:109], v[104:105], v[84:85] op_sel:[0,0] op_sel_hi:[0,1]
    v_cvt_pk_bf16_f32 v101, v112, v113
    v_pk_fma_f32 v[106:107], v[104:105], v[84:85], v[108:109] op_sel:[1,1,0] op_sel_hi:[1,0,1] neg_lo:[0,1,0]
    v_cvt_pk_bf16_f32 v110, v106, v107
    ds_write_b32 v24, v101 offset:4624
    ds_write_b32 v24, v110 offset:13056
    v_pk_mul_f32 v[96:97], v[112:113], v[86:87] op_sel:[0,0] op_sel_hi:[0,1] neg_hi:[0,1]
    v_pk_mul_f32 v[108:109], v[106:107], v[84:85] op_sel:[0,0] op_sel_hi:[0,1]
    v_pk_fma_f32 v[104:105], v[106:107], v[84:85], v[108:109] op_sel:[1,1,0] op_sel_hi:[1,0,1] neg_lo:[0,1,0]
    v_pk_fma_f32 v[112:113], v[112:113], v[86:87], v[96:97] op_sel:[1,1,0] op_sel_hi:[1,0,1]
    v_cvt_pk_bf16_f32 v111, v104, v105
    v_cvt_pk_bf16_f32 v102, v112, v113
    ds_write_b32 v24, v111 offset:13328
    v_pk_mul_f32 v[108:109], v[104:105], v[84:85] op_sel:[0,0] op_sel_hi:[0,1]
    ds_write_b32 v24, v102 offset:4896
    v_pk_fma_f32 v[106:107], v[104:105], v[84:85], v[108:109] op_sel:[1,1,0] op_sel_hi:[1,0,1] neg_lo:[0,1,0]
    v_pk_mul_f32 v[96:97], v[112:113], v[86:87] op_sel:[0,0] op_sel_hi:[0,1] neg_hi:[0,1]
    v_cvt_pk_bf16_f32 v110, v106, v107
    ds_write_b32 v24, v110 offset:13600
    v_pk_fma_f32 v[112:113], v[112:113], v[86:87], v[96:97] op_sel:[1,1,0] op_sel_hi:[1,0,1]
    v_pk_mul_f32 v[108:109], v[106:107], v[84:85] op_sel:[0,0] op_sel_hi:[0,1]
    v_cvt_pk_bf16_f32 v103, v112, v113
    v_pk_fma_f32 v[104:105], v[106:107], v[84:85], v[108:109] op_sel:[1,1,0] op_sel_hi:[1,0,1] neg_lo:[0,1,0]
    v_cvt_pk_bf16_f32 v111, v104, v105
    ds_write_b32 v24, v103 offset:5168
    ds_write_b32 v24, v111 offset:13872
    v_pk_mul_f32 v[96:97], v[112:113], v[86:87] op_sel:[0,0] op_sel_hi:[0,1] neg_hi:[0,1]
    v_pk_mul_f32 v[108:109], v[104:105], v[84:85] op_sel:[0,0] op_sel_hi:[0,1]
    v_pk_fma_f32 v[106:107], v[104:105], v[84:85], v[108:109] op_sel:[1,1,0] op_sel_hi:[1,0,1] neg_lo:[0,1,0]
    v_pk_fma_f32 v[112:113], v[112:113], v[86:87], v[96:97] op_sel:[1,1,0] op_sel_hi:[1,0,1]
    v_cvt_pk_bf16_f32 v110, v106, v107
    v_cvt_pk_bf16_f32 v100, v112, v113
    ds_write_b32 v24, v110 offset:14144
    ds_write_b32 v24, v100 offset:5440
    s_waitcnt lgkmcnt(0)
    ds_read_b128 v[128:131], v25 offset:0
    ds_read_b128 v[132:135], v25 offset:5712
    ds_read_b128 v[136:139], v25 offset:32
    ds_read_b128 v[140:143], v25 offset:5744
    ds_read_b128 v[144:147], v25 offset:64
    ds_read_b128 v[148:151], v25 offset:5776
    ds_read_b128 v[152:155], v25 offset:96
    ds_read_b128 v[156:159], v25 offset:5808
    ds_read_b128 v[160:163], v25 offset:128
    ds_read_b128 v[164:167], v25 offset:5840
    ds_read_b128 v[168:171], v25 offset:160
    ds_read_b128 v[172:175], v25 offset:5872
    ds_read_b128 v[176:179], v25 offset:192
    ds_read_b128 v[180:183], v25 offset:5904
    s_waitcnt lgkmcnt(12)
    v_mfma_f32_32x32x16_bf16 v[64:79], v[128:131], v[132:135], v[64:79]
    ds_read_b128 v[184:187], v25 offset:224
    ds_read_b128 v[188:191], v25 offset:5936
    v_lshlrev_b32 v12, 16, v12
    v_lshlrev_b32 v15, 16, v15
    v_mul_f32 v12, 0x3fb8aa3b, v12
    v_lshlrev_b32 v18, 16, v18
    v_exp_f32 v12, v12
    s_waitcnt lgkmcnt(12)
    v_mfma_f32_32x32x16_bf16 v[64:79], v[136:139], v[140:143], v[64:79]
    v_lshlrev_b32 v21, 16, v21
    v_mul_f32 v81, v15, v31
    v_cvt_pk_bf16_f32 v12, v12, v12
    v_mul_f32 v98, v18, v9
    v_lshlrev_b32 v12, 16, v12
    v_mul_f32 v99, v21, v9
    s_waitcnt lgkmcnt(10)
    v_mfma_f32_32x32x16_bf16 v[64:79], v[144:147], v[148:151], v[64:79]
    v_mul_f32 v80, v12, v30
    v_sub_f32 v99, 0, v99
    v_sub_f32 v80, 0, v80
    v_mul_f32 v114, 0x3f800000, v80
    v_mul_f32 v117, 0x3f800000, v81
    s_waitcnt lgkmcnt(8)
    v_mfma_f32_32x32x16_bf16 v[64:79], v[152:155], v[156:159], v[64:79]
    v_mul_f32 v115, 0x41000000, v80
    v_mul_f32 v118, 0x41000000, v81
    v_mul_f32 v116, 0x43800000, v80
    v_mul_f32 v119, 0x43800000, v81
    v_exp_f32 v114, v114
    v_fract_f32 v117, v117
    s_waitcnt lgkmcnt(6)
    v_mfma_f32_32x32x16_bf16 v[64:79], v[160:163], v[164:167], v[64:79]
    v_exp_f32 v115, v115
    v_fract_f32 v118, v118
    v_exp_f32 v116, v116
    v_fract_f32 v119, v119
    v_cos_f32 v82, v117
    s_waitcnt lgkmcnt(4)
    v_mfma_f32_32x32x16_bf16 v[64:79], v[168:171], v[172:175], v[64:79]
    v_sin_f32 v83, v117
    v_cos_f32 v84, v118
    v_sin_f32 v85, v118
    v_cos_f32 v86, v119
    v_sin_f32 v87, v119
    s_nop 0
    s_waitcnt lgkmcnt(2)
    v_mfma_f32_32x32x16_bf16 v[64:79], v[176:179], v[180:183], v[64:79]
    v_mul_f32 v82, v82, v114
    v_mul_f32 v83, v83, v114
    v_mul_f32 v84, v84, v115
    v_mul_f32 v85, v85, v115
    v_mul_f32 v86, v86, v116
    s_waitcnt lgkmcnt(0)
    v_mfma_f32_32x32x16_bf16 v[64:79], v[184:187], v[188:191], v[64:79]
    v_mul_f32 v87, v87, v116
    v_pk_mul_f32 v[96:97], v[82:83], v[82:83] op_sel:[0,0] op_sel_hi:[0,1]
    v_pk_fma_f32 v[88:89], v[82:83], v[82:83], v[96:97] op_sel:[1,1,0] op_sel_hi:[1,0,1] neg_lo:[0,1,0]
    s_nop 0
    v_pk_mul_f32 v[96:97], v[88:89], v[88:89] op_sel:[0,0] op_sel_hi:[0,1]
    v_pk_fma_f32 v[90:91], v[88:89], v[88:89], v[96:97] op_sel:[1,1,0] op_sel_hi:[1,0,1] neg_lo:[0,1,0]
    v_cvt_pk_bf16_f32 v110, v84, v85
    ds_write_b32 v24, v110 offset:5984
    v_cvt_pk_bf16_f32 v100, v98, v99
    v_pk_mul_f32 v[108:109], v[84:85], v[84:85] op_sel:[0,0] op_sel_hi:[0,1]
    ds_write_b32 v24, v100 offset:0
    v_pk_fma_f32 v[104:105], v[84:85], v[84:85], v[108:109] op_sel:[1,1,0] op_sel_hi:[1,0,1] neg_lo:[0,1,0]
    v_cvt_pk_bf16_f32 v111, v104, v105
    v_pk_mul_f32 v[96:97], v[98:99], v[82:83] op_sel:[0,0] op_sel_hi:[0,1] neg_hi:[0,1]
    ds_write_b32 v24, v111 offset:6256
    v_pk_fma_f32 v[92:93], v[98:99], v[82:83], v[96:97] op_sel:[1,1,0] op_sel_hi:[1,0,1]
    v_pk_mul_f32 v[108:109], v[104:105], v[84:85] op_sel:[0,0] op_sel_hi:[0,1]
    v_pk_fma_f32 v[106:107], v[104:105], v[84:85], v[108:109] op_sel:[1,1,0] op_sel_hi:[1,0,1] neg_lo:[0,1,0]
    v_cvt_pk_bf16_f32 v101, v92, v93
    v_cvt_pk_bf16_f32 v110, v106, v107
    ds_write_b32 v24, v101 offset:272
    ds_write_b32 v24, v110 offset:6528
    v_pk_mul_f32 v[108:109], v[106:107], v[84:85] op_sel:[0,0] op_sel_hi:[0,1]
    v_pk_mul_f32 v[96:97], v[92:93], v[82:83] op_sel:[0,0] op_sel_hi:[0,1] neg_hi:[0,1]
    v_pk_fma_f32 v[104:105], v[106:107], v[84:85], v[108:109] op_sel:[1,1,0] op_sel_hi:[1,0,1] neg_lo:[0,1,0]
    v_pk_fma_f32 v[94:95], v[92:93], v[82:83], v[96:97] op_sel:[1,1,0] op_sel_hi:[1,0,1]
    v_cvt_pk_bf16_f32 v111, v104, v105
    ds_write_b32 v24, v111 offset:6800
    v_cvt_pk_bf16_f32 v102, v94, v95
    v_pk_mul_f32 v[108:109], v[104:105], v[84:85] op_sel:[0,0] op_sel_hi:[0,1]
    ds_write_b32 v24, v102 offset:544
    v_pk_fma_f32 v[106:107], v[104:105], v[84:85], v[108:109] op_sel:[1,1,0] op_sel_hi:[1,0,1] neg_lo:[0,1,0]
    v_cvt_pk_bf16_f32 v110, v106, v107
    v_pk_mul_f32 v[96:97], v[94:95], v[82:83] op_sel:[0,0] op_sel_hi:[0,1] neg_hi:[0,1]
    ds_write_b32 v24, v110 offset:7072
    v_pk_fma_f32 v[92:93], v[94:95], v[82:83], v[96:97] op_sel:[1,1,0] op_sel_hi:[1,0,1]
    v_pk_mul_f32 v[108:109], v[106:107], v[84:85] op_sel:[0,0] op_sel_hi:[0,1]
    v_pk_fma_f32 v[104:105], v[106:107], v[84:85], v[108:109] op_sel:[1,1,0] op_sel_hi:[1,0,1] neg_lo:[0,1,0]
    v_cvt_pk_bf16_f32 v103, v92, v93
    v_cvt_pk_bf16_f32 v111, v104, v105
    ds_write_b32 v24, v103 offset:816
    ds_write_b32 v24, v111 offset:7344
    v_pk_mul_f32 v[108:109], v[104:105], v[84:85] op_sel:[0,0] op_sel_hi:[0,1]
    v_pk_mul_f32 v[96:97], v[92:93], v[82:83] op_sel:[0,0] op_sel_hi:[0,1] neg_hi:[0,1]
    v_pk_fma_f32 v[106:107], v[104:105], v[84:85], v[108:109] op_sel:[1,1,0] op_sel_hi:[1,0,1] neg_lo:[0,1,0]
    v_pk_fma_f32 v[94:95], v[92:93], v[82:83], v[96:97] op_sel:[1,1,0] op_sel_hi:[1,0,1]
    v_cvt_pk_bf16_f32 v110, v106, v107
    ds_write_b32 v24, v110 offset:7616
    v_cvt_pk_bf16_f32 v100, v94, v95
    v_pk_mul_f32 v[108:109], v[106:107], v[84:85] op_sel:[0,0] op_sel_hi:[0,1]
    ds_write_b32 v24, v100 offset:1088
    v_pk_fma_f32 v[104:105], v[106:107], v[84:85], v[108:109] op_sel:[1,1,0] op_sel_hi:[1,0,1] neg_lo:[0,1,0]
    v_cvt_pk_bf16_f32 v111, v104, v105
    v_pk_mul_f32 v[96:97], v[94:95], v[82:83] op_sel:[0,0] op_sel_hi:[0,1] neg_hi:[0,1]
    ds_write_b32 v24, v111 offset:7888
    v_pk_fma_f32 v[92:93], v[94:95], v[82:83], v[96:97] op_sel:[1,1,0] op_sel_hi:[1,0,1]
    v_pk_mul_f32 v[108:109], v[104:105], v[84:85] op_sel:[0,0] op_sel_hi:[0,1]
    v_pk_fma_f32 v[106:107], v[104:105], v[84:85], v[108:109] op_sel:[1,1,0] op_sel_hi:[1,0,1] neg_lo:[0,1,0]
    v_cvt_pk_bf16_f32 v101, v92, v93
    v_cvt_pk_bf16_f32 v110, v106, v107
    ds_write_b32 v24, v101 offset:1360
    ds_write_b32 v24, v110 offset:8160
    v_pk_mul_f32 v[108:109], v[106:107], v[84:85] op_sel:[0,0] op_sel_hi:[0,1]
    v_pk_mul_f32 v[96:97], v[92:93], v[82:83] op_sel:[0,0] op_sel_hi:[0,1] neg_hi:[0,1]
    v_pk_fma_f32 v[104:105], v[106:107], v[84:85], v[108:109] op_sel:[1,1,0] op_sel_hi:[1,0,1] neg_lo:[0,1,0]
    v_pk_fma_f32 v[94:95], v[92:93], v[82:83], v[96:97] op_sel:[1,1,0] op_sel_hi:[1,0,1]
    v_cvt_pk_bf16_f32 v111, v104, v105
    ds_write_b32 v24, v111 offset:8432
    v_cvt_pk_bf16_f32 v102, v94, v95
    v_pk_mul_f32 v[108:109], v[104:105], v[84:85] op_sel:[0,0] op_sel_hi:[0,1]
    ds_write_b32 v24, v102 offset:1632
    v_pk_fma_f32 v[106:107], v[104:105], v[84:85], v[108:109] op_sel:[1,1,0] op_sel_hi:[1,0,1] neg_lo:[0,1,0]
    v_cvt_pk_bf16_f32 v110, v106, v107
    v_pk_mul_f32 v[96:97], v[94:95], v[82:83] op_sel:[0,0] op_sel_hi:[0,1] neg_hi:[0,1]
    ds_write_b32 v24, v110 offset:8704
    v_pk_fma_f32 v[92:93], v[94:95], v[82:83], v[96:97] op_sel:[1,1,0] op_sel_hi:[1,0,1]
    v_pk_mul_f32 v[108:109], v[106:107], v[84:85] op_sel:[0,0] op_sel_hi:[0,1]
    v_pk_fma_f32 v[104:105], v[106:107], v[84:85], v[108:109] op_sel:[1,1,0] op_sel_hi:[1,0,1] neg_lo:[0,1,0]
    v_cvt_pk_bf16_f32 v103, v92, v93
    v_cvt_pk_bf16_f32 v111, v104, v105
    ds_write_b32 v24, v103 offset:1904
    ds_write_b32 v24, v111 offset:8976
    v_pk_mul_f32 v[108:109], v[104:105], v[84:85] op_sel:[0,0] op_sel_hi:[0,1]
    v_pk_mul_f32 v[96:97], v[98:99], v[86:87] op_sel:[0,0] op_sel_hi:[0,1] neg_hi:[0,1]
    v_pk_fma_f32 v[106:107], v[104:105], v[84:85], v[108:109] op_sel:[1,1,0] op_sel_hi:[1,0,1] neg_lo:[0,1,0]
    v_pk_fma_f32 v[112:113], v[98:99], v[86:87], v[96:97] op_sel:[1,1,0] op_sel_hi:[1,0,1]
    v_cvt_pk_bf16_f32 v110, v106, v107
    ds_write_b32 v24, v110 offset:9248
    v_cvt_pk_bf16_f32 v100, v112, v113
    v_pk_mul_f32 v[108:109], v[106:107], v[84:85] op_sel:[0,0] op_sel_hi:[0,1]
    ds_write_b32 v24, v100 offset:2176
    v_pk_fma_f32 v[104:105], v[106:107], v[84:85], v[108:109] op_sel:[1,1,0] op_sel_hi:[1,0,1] neg_lo:[0,1,0]
    v_cvt_pk_bf16_f32 v111, v104, v105
    v_pk_mul_f32 v[96:97], v[112:113], v[88:89] op_sel:[0,0] op_sel_hi:[0,1] neg_hi:[0,1]
    ds_write_b32 v24, v111 offset:9520
    v_pk_fma_f32 v[92:93], v[112:113], v[88:89], v[96:97] op_sel:[1,1,0] op_sel_hi:[1,0,1]
    v_pk_mul_f32 v[108:109], v[104:105], v[84:85] op_sel:[0,0] op_sel_hi:[0,1]
    v_pk_fma_f32 v[106:107], v[104:105], v[84:85], v[108:109] op_sel:[1,1,0] op_sel_hi:[1,0,1] neg_lo:[0,1,0]
    v_cvt_pk_bf16_f32 v101, v92, v93
    v_cvt_pk_bf16_f32 v110, v106, v107
    ds_write_b32 v24, v101 offset:2448
    ds_write_b32 v24, v110 offset:9792
    v_pk_mul_f32 v[108:109], v[106:107], v[84:85] op_sel:[0,0] op_sel_hi:[0,1]
    v_pk_mul_f32 v[96:97], v[92:93], v[88:89] op_sel:[0,0] op_sel_hi:[0,1] neg_hi:[0,1]
    v_pk_fma_f32 v[104:105], v[106:107], v[84:85], v[108:109] op_sel:[1,1,0] op_sel_hi:[1,0,1] neg_lo:[0,1,0]
    v_pk_fma_f32 v[94:95], v[92:93], v[88:89], v[96:97] op_sel:[1,1,0] op_sel_hi:[1,0,1]
    v_cvt_pk_bf16_f32 v111, v104, v105
    v_cvt_pk_bf16_f32 v102, v94, v95
    ds_write_b32 v24, v111 offset:10064
    v_pk_mul_f32 v[108:109], v[104:105], v[84:85] op_sel:[0,0] op_sel_hi:[0,1]
    ds_write_b32 v24, v102 offset:2720
    v_pk_fma_f32 v[106:107], v[104:105], v[84:85], v[108:109] op_sel:[1,1,0] op_sel_hi:[1,0,1] neg_lo:[0,1,0]
    v_pk_mul_f32 v[96:97], v[94:95], v[88:89] op_sel:[0,0] op_sel_hi:[0,1] neg_hi:[0,1]
    v_cvt_pk_bf16_f32 v110, v106, v107
    ds_write_b32 v24, v110 offset:10336
    v_pk_fma_f32 v[92:93], v[94:95], v[88:89], v[96:97] op_sel:[1,1,0] op_sel_hi:[1,0,1]
    v_pk_mul_f32 v[108:109], v[106:107], v[84:85] op_sel:[0,0] op_sel_hi:[0,1]
    v_cvt_pk_bf16_f32 v103, v92, v93
    v_pk_fma_f32 v[104:105], v[106:107], v[84:85], v[108:109] op_sel:[1,1,0] op_sel_hi:[1,0,1] neg_lo:[0,1,0]
    v_cvt_pk_bf16_f32 v111, v104, v105
    ds_write_b32 v24, v103 offset:2992
    ds_write_b32 v24, v111 offset:10608
    v_pk_mul_f32 v[96:97], v[112:113], v[86:87] op_sel:[0,0] op_sel_hi:[0,1] neg_hi:[0,1]
    v_pk_mul_f32 v[108:109], v[104:105], v[84:85] op_sel:[0,0] op_sel_hi:[0,1]
    v_pk_fma_f32 v[106:107], v[104:105], v[84:85], v[108:109] op_sel:[1,1,0] op_sel_hi:[1,0,1] neg_lo:[0,1,0]
    v_pk_fma_f32 v[112:113], v[112:113], v[86:87], v[96:97] op_sel:[1,1,0] op_sel_hi:[1,0,1]
    v_cvt_pk_bf16_f32 v110, v106, v107
    v_cvt_pk_bf16_f32 v100, v112, v113
    ds_write_b32 v24, v110 offset:10880
    v_pk_mul_f32 v[108:109], v[106:107], v[84:85] op_sel:[0,0] op_sel_hi:[0,1]
    ds_write_b32 v24, v100 offset:3264
    v_pk_fma_f32 v[104:105], v[106:107], v[84:85], v[108:109] op_sel:[1,1,0] op_sel_hi:[1,0,1] neg_lo:[0,1,0]
    v_pk_mul_f32 v[96:97], v[112:113], v[90:91] op_sel:[0,0] op_sel_hi:[0,1] neg_hi:[0,1]
    v_cvt_pk_bf16_f32 v111, v104, v105
    ds_write_b32 v24, v111 offset:11152
    v_pk_fma_f32 v[92:93], v[112:113], v[90:91], v[96:97] op_sel:[1,1,0] op_sel_hi:[1,0,1]
    v_pk_mul_f32 v[108:109], v[104:105], v[84:85] op_sel:[0,0] op_sel_hi:[0,1]
    v_cvt_pk_bf16_f32 v101, v92, v93
    v_pk_fma_f32 v[106:107], v[104:105], v[84:85], v[108:109] op_sel:[1,1,0] op_sel_hi:[1,0,1] neg_lo:[0,1,0]
    v_cvt_pk_bf16_f32 v110, v106, v107
    ds_write_b32 v24, v101 offset:3536
    ds_write_b32 v24, v110 offset:11424
    v_pk_mul_f32 v[96:97], v[112:113], v[86:87] op_sel:[0,0] op_sel_hi:[0,1] neg_hi:[0,1]
    v_pk_mul_f32 v[108:109], v[106:107], v[84:85] op_sel:[0,0] op_sel_hi:[0,1]
    v_pk_fma_f32 v[104:105], v[106:107], v[84:85], v[108:109] op_sel:[1,1,0] op_sel_hi:[1,0,1] neg_lo:[0,1,0]
    v_pk_fma_f32 v[112:113], v[112:113], v[86:87], v[96:97] op_sel:[1,1,0] op_sel_hi:[1,0,1]
    v_cvt_pk_bf16_f32 v111, v104, v105
    v_cvt_pk_bf16_f32 v102, v112, v113
    ds_write_b32 v24, v111 offset:11696
    v_pk_mul_f32 v[108:109], v[104:105], v[84:85] op_sel:[0,0] op_sel_hi:[0,1]
    ds_write_b32 v24, v102 offset:3808
    v_pk_fma_f32 v[106:107], v[104:105], v[84:85], v[108:109] op_sel:[1,1,0] op_sel_hi:[1,0,1] neg_lo:[0,1,0]
    v_pk_mul_f32 v[96:97], v[112:113], v[90:91] op_sel:[0,0] op_sel_hi:[0,1] neg_hi:[0,1]
    v_cvt_pk_bf16_f32 v110, v106, v107
    ds_write_b32 v24, v110 offset:11968
    v_pk_fma_f32 v[92:93], v[112:113], v[90:91], v[96:97] op_sel:[1,1,0] op_sel_hi:[1,0,1]
    v_pk_mul_f32 v[108:109], v[106:107], v[84:85] op_sel:[0,0] op_sel_hi:[0,1]
    v_cvt_pk_bf16_f32 v103, v92, v93
    v_pk_fma_f32 v[104:105], v[106:107], v[84:85], v[108:109] op_sel:[1,1,0] op_sel_hi:[1,0,1] neg_lo:[0,1,0]
    v_cvt_pk_bf16_f32 v111, v104, v105
    ds_write_b32 v24, v103 offset:4080
    ds_write_b32 v24, v111 offset:12240
    v_pk_mul_f32 v[96:97], v[112:113], v[86:87] op_sel:[0,0] op_sel_hi:[0,1] neg_hi:[0,1]
    v_pk_mul_f32 v[108:109], v[104:105], v[84:85] op_sel:[0,0] op_sel_hi:[0,1]
    v_pk_fma_f32 v[106:107], v[104:105], v[84:85], v[108:109] op_sel:[1,1,0] op_sel_hi:[1,0,1] neg_lo:[0,1,0]
    v_pk_fma_f32 v[112:113], v[112:113], v[86:87], v[96:97] op_sel:[1,1,0] op_sel_hi:[1,0,1]
    v_cvt_pk_bf16_f32 v110, v106, v107
    v_cvt_pk_bf16_f32 v100, v112, v113
    ds_write_b32 v24, v110 offset:12512
    s_cmp_lg_u32 s30, 0
    s_cbranch_scc1 K12_CV_NOPOLL
    buffer_load_dword v236, v3, s[44:47], 0 offen offset:128 sc1
K12_CV_NOPOLL:
    v_pk_mul_f32 v[108:109], v[106:107], v[84:85] op_sel:[0,0] op_sel_hi:[0,1]
    ds_write_b32 v24, v100 offset:4352
    v_pk_fma_f32 v[104:105], v[106:107], v[84:85], v[108:109] op_sel:[1,1,0] op_sel_hi:[1,0,1] neg_lo:[0,1,0]
    v_pk_mul_f32 v[96:97], v[112:113], v[86:87] op_sel:[0,0] op_sel_hi:[0,1] neg_hi:[0,1]
    v_cvt_pk_bf16_f32 v111, v104, v105
    ds_write_b32 v24, v111 offset:12784
    v_pk_fma_f32 v[112:113], v[112:113], v[86:87], v[96:97] op_sel:[1,1,0] op_sel_hi:[1,0,1]
    v_pk_mul_f32 v[108:109], v[104:105], v[84:85] op_sel:[0,0] op_sel_hi:[0,1]
    v_cvt_pk_bf16_f32 v101, v112, v113
    v_pk_fma_f32 v[106:107], v[104:105], v[84:85], v[108:109] op_sel:[1,1,0] op_sel_hi:[1,0,1] neg_lo:[0,1,0]
    v_cvt_pk_bf16_f32 v110, v106, v107
    ds_write_b32 v24, v101 offset:4624
    ds_write_b32 v24, v110 offset:13056
    v_pk_mul_f32 v[96:97], v[112:113], v[86:87] op_sel:[0,0] op_sel_hi:[0,1] neg_hi:[0,1]
    v_pk_mul_f32 v[108:109], v[106:107], v[84:85] op_sel:[0,0] op_sel_hi:[0,1]
    v_pk_fma_f32 v[104:105], v[106:107], v[84:85], v[108:109] op_sel:[1,1,0] op_sel_hi:[1,0,1] neg_lo:[0,1,0]
    v_pk_fma_f32 v[112:113], v[112:113], v[86:87], v[96:97] op_sel:[1,1,0] op_sel_hi:[1,0,1]
    v_cvt_pk_bf16_f32 v111, v104, v105
    v_cvt_pk_bf16_f32 v102, v112, v113
    ds_write_b32 v24, v111 offset:13328
    v_pk_mul_f32 v[108:109], v[104:105], v[84:85] op_sel:[0,0] op_sel_hi:[0,1]
    ds_write_b32 v24, v102 offset:4896
    v_pk_fma_f32 v[106:107], v[104:105], v[84:85], v[108:109] op_sel:[1,1,0] op_sel_hi:[1,0,1] neg_lo:[0,1,0]
    v_pk_mul_f32 v[96:97], v[112:113], v[86:87] op_sel:[0,0] op_sel_hi:[0,1] neg_hi:[0,1]
    v_cvt_pk_bf16_f32 v110, v106, v107
    ds_write_b32 v24, v110 offset:13600
    v_pk_fma_f32 v[112:113], v[112:113], v[86:87], v[96:97] op_sel:[1,1,0] op_sel_hi:[1,0,1]
    v_pk_mul_f32 v[108:109], v[106:107], v[84:85] op_sel:[0,0] op_sel_hi:[0,1]
    v_cvt_pk_bf16_f32 v103, v112, v113
    v_pk_fma_f32 v[104:105], v[106:107], v[84:85], v[108:109] op_sel:[1,1,0] op_sel_hi:[1,0,1] neg_lo:[0,1,0]
    v_cvt_pk_bf16_f32 v111, v104, v105
    ds_write_b32 v24, v103 offset:5168
    ds_write_b32 v24, v111 offset:13872
    v_pk_mul_f32 v[96:97], v[112:113], v[86:87] op_sel:[0,0] op_sel_hi:[0,1] neg_hi:[0,1]
    v_pk_mul_f32 v[108:109], v[104:105], v[84:85] op_sel:[0,0] op_sel_hi:[0,1]
    v_pk_fma_f32 v[106:107], v[104:105], v[84:85], v[108:109] op_sel:[1,1,0] op_sel_hi:[1,0,1] neg_lo:[0,1,0]
    v_pk_fma_f32 v[112:113], v[112:113], v[86:87], v[96:97] op_sel:[1,1,0] op_sel_hi:[1,0,1]
    v_cvt_pk_bf16_f32 v110, v106, v107
    v_cvt_pk_bf16_f32 v100, v112, v113
    ds_write_b32 v24, v110 offset:14144
    ds_write_b32 v24, v100 offset:5440
    s_cmp_lg_u32 s30, 0
    s_cbranch_scc1 K12_CV_BAR
    s_mov_b32 s70, 4096
    s_branch K12_CV_CHK
K12_CV_LOOP:
    s_sleep 8
    buffer_load_dword v236, v3, s[44:47], 0 offen offset:128 sc1
K12_CV_CHK:
    s_waitcnt vmcnt(0)
    v_readfirstlane_b32 s71, v236
    s_sub_u32 s70, s70, 1
    s_cmp_eq_u32 s70, 0
    s_cbranch_scc1 K12_CV_OK
    s_cmp_lt_u32 s71, 1
    s_cbranch_scc1 K12_CV_LOOP
K12_CV_OK:
K12_CV_BAR:
    s_barrier
    v_lshlrev_b32 v4, 6, v0
    buffer_load_dwordx4 v[208:211], v4, s[52:55], 0 offen offset:0 sc1
    buffer_load_dwordx4 v[212:215], v4, s[52:55], 0 offen offset:16 sc1
    buffer_load_dwordx4 v[216:219], v4, s[52:55], 0 offen offset:32 sc1
    buffer_load_dwordx4 v[220:223], v4, s[52:55], 0 offen offset:48 sc1
    s_lshl_b32 s38, s37, 4
    s_add_u32 s39, s38, 0
    buffer_load_dwordx4 v[224:227], v3, s[48:51], s39 offen sc1
    s_add_u32 s39, s38, 2560
    buffer_load_dwordx4 v[228:231], v3, s[48:51], s39 offen sc1
    s_add_u32 s39, s38, 5120
    buffer_load_dwordx4 v[232:235], v3, s[48:51], s39 offen sc1
    s_waitcnt lgkmcnt(0)
    ds_read_b128 v[128:131], v25 offset:0
    ds_read_b128 v[132:135], v25 offset:5712
    ds_read_b128 v[136:139], v25 offset:32
    ds_read_b128 v[140:143], v25 offset:5744
    ds_read_b128 v[144:147], v25 offset:64
    ds_read_b128 v[148:151], v25 offset:5776
    ds_read_b128 v[152:155], v25 offset:96
    ds_read_b128 v[156:159], v25 offset:5808
    ds_read_b128 v[160:163], v25 offset:128
    ds_read_b128 v[164:167], v25 offset:5840
    ds_read_b128 v[168:171], v25 offset:160
    ds_read_b128 v[172:175], v25 offset:5872
    ds_read_b128 v[176:179], v25 offset:192
    ds_read_b128 v[180:183], v25 offset:5904
    s_waitcnt lgkmcnt(12)
    v_mfma_f32_32x32x16_bf16 v[64:79], v[128:131], v[132:135], v[64:79]
    ds_read_b128 v[184:187], v25 offset:224
    ds_read_b128 v[188:191], v25 offset:5936
    s_waitcnt lgkmcnt(12)
    v_mfma_f32_32x32x16_bf16 v[64:79], v[136:139], v[140:143], v[64:79]
    s_waitcnt lgkmcnt(10)
    v_mfma_f32_32x32x16_bf16 v[64:79], v[144:147], v[148:151], v[64:79]
    s_waitcnt lgkmcnt(8)
    v_mfma_f32_32x32x16_bf16 v[64:79], v[152:155], v[156:159], v[64:79]
    s_waitcnt lgkmcnt(6)
    v_mfma_f32_32x32x16_bf16 v[64:79], v[160:163], v[164:167], v[64:79]
    s_waitcnt lgkmcnt(4)
    v_mfma_f32_32x32x16_bf16 v[64:79], v[168:171], v[172:175], v[64:79]
    s_waitcnt lgkmcnt(2)
    v_mfma_f32_32x32x16_bf16 v[64:79], v[176:179], v[180:183], v[64:79]
    s_waitcnt lgkmcnt(0)
    v_mfma_f32_32x32x16_bf16 v[64:79], v[184:187], v[188:191], v[64:79]
    s_nop 7
    s_nop 7
    v_cvt_pk_bf16_f32 v100, v64, v65
    v_cvt_pk_bf16_f32 v101, v66, v67
    v_cvt_pk_bf16_f32 v102, v68, v69
    v_cvt_pk_bf16_f32 v103, v70, v71
    v_cvt_pk_bf16_f32 v104, v72, v73
    v_cvt_pk_bf16_f32 v105, v74, v75
    ds_write_b64 v26, v[100:101]
    ds_write_b32 v27, v102
    ds_write_b32 v28, v103
    ds_write_b16 v29, v104
    ds_write_b16_d16_hi v29, v104 offset:64
    ds_write_b16 v29, v105 offset:128
    ds_write_b16_d16_hi v29, v105 offset:192
    s_waitcnt lgkmcnt(0)
    ds_read_u16 v128, v32
    ds_read_u16 v129, v33
    ds_read_u16 v130, v34
    ds_read_u16 v131, v35
    ds_read_u16 v132, v36
    ds_read_u16 v133, v37
    ds_read_u16 v134, v38
    ds_read_u16 v135, v39
    ds_read_u16 v136, v40
    ds_read_u16 v137, v41
    ds_read_u16 v138, v42
    ds_read_u16 v139, v43
    ds_read_u16 v140, v44
    ds_read_u16 v141, v45
    ds_read_u16 v142, v46
    ds_read_u16 v143, v47
    s_waitcnt lgkmcnt(8)
    v_lshl_or_b32 v160, v129, 16, v128
    v_lshl_or_b32 v161, v131, 16, v130
    v_lshl_or_b32 v162, v133, 16, v132
    v_lshl_or_b32 v163, v135, 16, v134
    ds_read_u16 v144, v48
    ds_read_u16 v145, v49
    ds_read_u16 v146, v50
    ds_read_u16 v147, v51
    ds_read_u16 v148, v52
    ds_read_u16 v149, v53
    ds_read_u16 v150, v54
    ds_read_u16 v151, v55
    s_waitcnt lgkmcnt(8)
    v_lshl_or_b32 v164, v137, 16, v136
    v_lshl_or_b32 v165, v139, 16, v138
    v_lshl_or_b32 v166, v141, 16, v140
    v_lshl_or_b32 v167, v143, 16, v142
    ds_read_u16 v152, v56
    ds_read_u16 v153, v57
    ds_read_u16 v154, v58
    ds_read_u16 v155, v59
    ds_read_u16 v156, v60
    ds_read_u16 v157, v61
    ds_read_u16 v158, v62
    ds_read_u16 v159, v63
    s_waitcnt lgkmcnt(8)
    v_lshl_or_b32 v168, v145, 16, v144
    v_lshl_or_b32 v169, v147, 16, v146
    v_lshl_or_b32 v170, v149, 16, v148
    v_lshl_or_b32 v171, v151, 16, v150
    s_waitcnt lgkmcnt(0)
    v_lshl_or_b32 v172, v153, 16, v152
    v_lshl_or_b32 v173, v155, 16, v154
    v_lshl_or_b32 v174, v157, 16, v156
    v_lshl_or_b32 v175, v159, 16, v158
    s_nop 1
    v_mov_b32_dpp v131, v160 wave_shl:1 row_mask:0xf bank_mask:0xf bound_ctrl:0
    v_mov_b32_dpp v144, v161 wave_shl:1 row_mask:0xf bank_mask:0xf bound_ctrl:0
    v_mov_b32_dpp v135, v164 wave_shl:1 row_mask:0xf bank_mask:0xf bound_ctrl:0
    v_mov_b32_dpp v145, v165 wave_shl:1 row_mask:0xf bank_mask:0xf bound_ctrl:0
    v_mov_b32_dpp v139, v168 wave_shl:1 row_mask:0xf bank_mask:0xf bound_ctrl:0
    v_mov_b32_dpp v146, v169 wave_shl:1 row_mask:0xf bank_mask:0xf bound_ctrl:0
    v_mov_b32_dpp v143, v172 wave_shl:1 row_mask:0xf bank_mask:0xf bound_ctrl:0
    v_mov_b32_dpp v147, v173 wave_shl:1 row_mask:0xf bank_mask:0xf bound_ctrl:0
    v_readlane_b32 s64, v164, 0
    v_readlane_b32 s65, v165, 0
    v_readlane_b32 s66, v168, 0
    v_readlane_b32 s67, v169, 0
    v_readlane_b32 s68, v172, 0
    v_readlane_b32 s69, v173, 0
    v_lshlrev_b32 v4, 4, v1
    v_add_u32 v8, s33, v4
    v_mov_b32 v128, v161
    v_mov_b32 v129, v162
    v_mov_b32 v130, v163
    v_mov_b32 v132, v165
    v_mov_b32 v133, v166
    v_mov_b32 v134, v167
    v_mov_b32 v136, v169
    v_mov_b32 v137, v170
    v_mov_b32 v138, v171
    v_mov_b32 v140, v173
    v_mov_b32 v141, v174
    v_mov_b32 v142, v175
    v_writelane_b32 v131, s64, 63
    v_writelane_b32 v144, s65, 63
    v_writelane_b32 v135, s66, 63
    v_writelane_b32 v145, s67, 63
    v_writelane_b32 v139, s68, 63
    v_writelane_b32 v146, s69, 63
    ds_write_b128 v8, v[160:163] offset:0
    ds_write_b128 v8, v[164:167] offset:1024
    ds_write_b128 v8, v[168:171] offset:2048
    ds_write_b128 v8, v[172:175] offset:3072
    s_nop 1
    v_alignbit_b32 v64, v128, v160, 16
    v_alignbit_b32 v65, v129, v161, 16
    v_alignbit_b32 v66, v130, v162, 16
    v_alignbit_b32 v67, v131, v163, 16
    v_alignbit_b32 v80, v129, v128, 16
    v_alignbit_b32 v81, v130, v129, 16
    v_alignbit_b32 v82, v131, v130, 16
    v_alignbit_b32 v83, v144, v131, 16
    ds_write_b128 v8, v[128:131] offset:8192
    ds_write_b128 v8, v[64:67] offset:4096
    ds_write_b128 v8, v[80:83] offset:12288
    v_alignbit_b32 v68, v132, v164, 16
    v_alignbit_b32 v69, v133, v165, 16
    v_alignbit_b32 v70, v134, v166, 16
    v_alignbit_b32 v71, v135, v167, 16
    v_alignbit_b32 v84, v133, v132, 16
    v_alignbit_b32 v85, v134, v133, 16
    v_alignbit_b32 v86, v135, v134, 16
    v_alignbit_b32 v87, v145, v135, 16
    ds_write_b128 v8, v[132:135] offset:9216
    ds_write_b128 v8, v[68:71] offset:5120
    ds_write_b128 v8, v[84:87] offset:13312
    v_alignbit_b32 v72, v136, v168, 16
    v_alignbit_b32 v73, v137, v169, 16
    v_alignbit_b32 v74, v138, v170, 16
    v_alignbit_b32 v75, v139, v171, 16
    v_alignbit_b32 v88, v137, v136, 16
    v_alignbit_b32 v89, v138, v137, 16
    v_alignbit_b32 v90, v139, v138, 16
    v_alignbit_b32 v91, v146, v139, 16
    ds_write_b128 v8, v[136:139] offset:10240
    ds_write_b128 v8, v[72:75] offset:6144
    ds_write_b128 v8, v[88:91] offset:14336
    v_alignbit_b32 v76, v140, v172, 16
    v_alignbit_b32 v77, v141, v173, 16
    v_alignbit_b32 v78, v142, v174, 16
    v_alignbit_b32 v79, v143, v175, 16
    v_alignbit_b32 v92, v141, v140, 16
    v_alignbit_b32 v93, v142, v141, 16
    v_alignbit_b32 v94, v143, v142, 16
    v_alignbit_b32 v95, v147, v143, 16
    ds_write_b128 v8, v[140:143] offset:11264
    ds_write_b128 v8, v[76:79] offset:7168
    ds_write_b128 v8, v[92:95] offset:15360
    s_mov_b32 s64, 0x05040100
    s_mov_b32 s65, 0x07060302
    s_waitcnt vmcnt(0)
    v_perm_b32 v240, v194, v192, s64
    v_perm_b32 v241, v198, v196, s64
    v_perm_b32 v242, v202, v200, s64
    v_perm_b32 v243, v206, v204, s64
    v_perm_b32 v244, v194, v192, s65
    v_perm_b32 v245, v198, v196, s65
    v_perm_b32 v246, v202, v200, s65
    v_perm_b32 v247, v206, v204, s65
    v_perm_b32 v248, v195, v193, s64
    v_perm_b32 v249, v199, v197, s64
    v_perm_b32 v250, v203, v201, s64
    v_perm_b32 v251, v207, v205, s64
    v_perm_b32 v252, v195, v193, s65
    v_perm_b32 v253, v199, v197, s65
    v_perm_b32 v254, v203, v201, s65
    v_perm_b32 v255, v207, v205, s65
    v_add_f32 v100, 1.0, v228
    v_add_f32 v102, 1.0, v229
    v_add_f32 v104, 1.0, v230
    v_add_f32 v106, 1.0, v231
    v_cvt_pk_bf16_f32 v100, v100, v100
    v_cvt_pk_bf16_f32 v102, v102, v102
    v_cvt_pk_bf16_f32 v104, v104, v104
    v_cvt_pk_bf16_f32 v106, v106, v106
    v_lshlrev_b32 v100, 16, v100
    v_mov_b32 v101, v224
    v_mov_b32 v109, v232
    v_lshlrev_b32 v102, 16, v102
    v_mov_b32 v103, v225
    v_mov_b32 v111, v233
    v_lshlrev_b32 v104, 16, v104
    v_mov_b32 v105, v226
    v_mov_b32 v113, v234
    v_lshlrev_b32 v106, 16, v106
    v_mov_b32 v107, v227
    v_mov_b32 v115, v235
    s_lshl_b32 s64, s62, 16
    s_and_b32 s65, s62, 0xffff0000
    s_lshl_b32 s66, s63, 16
    s_and_b32 s67, s63, 0xffff0000
    v_mov_b32 v108, s64
    v_mov_b32 v110, s65
    v_mov_b32 v112, s66
    v_mov_b32 v114, s67
    v_mov_b32 v20, v108
    v_mov_b32 v21, v109
    v_mov_b32 v22, v110
    v_mov_b32 v23, v111
    v_mov_b32 v24, v112
    v_mov_b32 v25, v113
    v_mov_b32 v26, v114
    v_mov_b32 v27, v115
    v_lshlrev_b32 v116, 16, v240
    v_lshlrev_b32 v118, 16, v244
    v_lshlrev_b32 v120, 16, v248
    v_lshlrev_b32 v122, 16, v252
    v_and_b32 v117, 0xffff0000, v240
    v_and_b32 v119, 0xffff0000, v244
    v_and_b32 v121, 0xffff0000, v248
    v_and_b32 v123, 0xffff0000, v252
    v_pk_fma_f32 v[116:117], v[116:117], v[208:209], v[216:217] neg_lo:[0,0,1] neg_hi:[0,0,1]
    v_pk_fma_f32 v[118:119], v[118:119], v[208:209], v[216:217] neg_lo:[0,0,1] neg_hi:[0,0,1]
    v_pk_fma_f32 v[120:121], v[120:121], v[208:209], v[216:217] neg_lo:[0,0,1] neg_hi:[0,0,1]
    v_pk_fma_f32 v[122:123], v[122:123], v[208:209], v[216:217] neg_lo:[0,0,1] neg_hi:[0,0,1]
    v_cvt_pk_bf16_f32 v116, v116, v117
    v_cvt_pk_bf16_f32 v118, v118, v119
    v_cvt_pk_bf16_f32 v120, v120, v121
    v_cvt_pk_bf16_f32 v122, v122, v123
    v_and_b32 v117, 0xffff0000, v116
    v_and_b32 v119, 0xffff0000, v118
    v_and_b32 v121, 0xffff0000, v120
    v_and_b32 v123, 0xffff0000, v122
    v_lshlrev_b32 v116, 16, v116
    v_lshlrev_b32 v118, 16, v118
    v_lshlrev_b32 v120, 16, v120
    v_lshlrev_b32 v122, 16, v122
    v_pk_fma_f32 v[116:117], v[116:117], v[100:101], v[100:101] op_sel:[0,0,1] op_sel_hi:[1,0,1]
    v_pk_fma_f32 v[118:119], v[118:119], v[102:103], v[102:103] op_sel:[0,0,1] op_sel_hi:[1,0,1]
    v_pk_fma_f32 v[120:121], v[120:121], v[104:105], v[104:105] op_sel:[0,0,1] op_sel_hi:[1,0,1]
    v_pk_fma_f32 v[122:123], v[122:123], v[106:107], v[106:107] op_sel:[0,0,1] op_sel_hi:[1,0,1]
    v_cvt_pk_bf16_f32 v192, v116, v117
    v_cvt_pk_bf16_f32 v196, v118, v119
    v_cvt_pk_bf16_f32 v200, v120, v121
    v_cvt_pk_bf16_f32 v204, v122, v123
    v_lshlrev_b32 v116, 16, v241
    v_lshlrev_b32 v118, 16, v245
    v_lshlrev_b32 v120, 16, v249
    v_lshlrev_b32 v122, 16, v253
    v_and_b32 v117, 0xffff0000, v241
    v_and_b32 v119, 0xffff0000, v245
    v_and_b32 v121, 0xffff0000, v249
    v_and_b32 v123, 0xffff0000, v253
    v_pk_fma_f32 v[116:117], v[116:117], v[210:211], v[218:219] neg_lo:[0,0,1] neg_hi:[0,0,1]
    v_pk_fma_f32 v[118:119], v[118:119], v[210:211], v[218:219] neg_lo:[0,0,1] neg_hi:[0,0,1]
    v_pk_fma_f32 v[120:121], v[120:121], v[210:211], v[218:219] neg_lo:[0,0,1] neg_hi:[0,0,1]
    v_pk_fma_f32 v[122:123], v[122:123], v[210:211], v[218:219] neg_lo:[0,0,1] neg_hi:[0,0,1]
    v_cvt_pk_bf16_f32 v116, v116, v117
    v_cvt_pk_bf16_f32 v118, v118, v119
    v_cvt_pk_bf16_f32 v120, v120, v121
    v_cvt_pk_bf16_f32 v122, v122, v123
    v_and_b32 v117, 0xffff0000, v116
    v_and_b32 v119, 0xffff0000, v118
    v_and_b32 v121, 0xffff0000, v120
    v_and_b32 v123, 0xffff0000, v122
    v_lshlrev_b32 v116, 16, v116
    v_lshlrev_b32 v118, 16, v118
    v_lshlrev_b32 v120, 16, v120
    v_lshlrev_b32 v122, 16, v122
    v_pk_fma_f32 v[116:117], v[116:117], v[100:101], v[100:101] op_sel:[0,0,1] op_sel_hi:[1,0,1]
    v_pk_fma_f32 v[118:119], v[118:119], v[102:103], v[102:103] op_sel:[0,0,1] op_sel_hi:[1,0,1]
    v_pk_fma_f32 v[120:121], v[120:121], v[104:105], v[104:105] op_sel:[0,0,1] op_sel_hi:[1,0,1]
    v_pk_fma_f32 v[122:123], v[122:123], v[106:107], v[106:107] op_sel:[0,0,1] op_sel_hi:[1,0,1]
    v_cvt_pk_bf16_f32 v193, v116, v117
    v_cvt_pk_bf16_f32 v197, v118, v119
    v_cvt_pk_bf16_f32 v201, v120, v121
    v_cvt_pk_bf16_f32 v205, v122, v123
    v_lshlrev_b32 v116, 16, v242
    v_lshlrev_b32 v118, 16, v246
    v_lshlrev_b32 v120, 16, v250
    v_lshlrev_b32 v122, 16, v254
    v_and_b32 v117, 0xffff0000, v242
    v_and_b32 v119, 0xffff0000, v246
    v_and_b32 v121, 0xffff0000, v250
    v_and_b32 v123, 0xffff0000, v254
    v_pk_fma_f32 v[116:117], v[116:117], v[212:213], v[220:221] neg_lo:[0,0,1] neg_hi:[0,0,1]
    v_pk_fma_f32 v[118:119], v[118:119], v[212:213], v[220:221] neg_lo:[0,0,1] neg_hi:[0,0,1]
    v_pk_fma_f32 v[120:121], v[120:121], v[212:213], v[220:221] neg_lo:[0,0,1] neg_hi:[0,0,1]
    v_pk_fma_f32 v[122:123], v[122:123], v[212:213], v[220:221] neg_lo:[0,0,1] neg_hi:[0,0,1]
    v_cvt_pk_bf16_f32 v116, v116, v117
    v_cvt_pk_bf16_f32 v118, v118, v119
    v_cvt_pk_bf16_f32 v120, v120, v121
    v_cvt_pk_bf16_f32 v122, v122, v123
    v_and_b32 v117, 0xffff0000, v116
    v_and_b32 v119, 0xffff0000, v118
    v_and_b32 v121, 0xffff0000, v120
    v_and_b32 v123, 0xffff0000, v122
    v_lshlrev_b32 v116, 16, v116
    v_lshlrev_b32 v118, 16, v118
    v_lshlrev_b32 v120, 16, v120
    v_lshlrev_b32 v122, 16, v122
    v_pk_fma_f32 v[116:117], v[116:117], v[100:101], v[100:101] op_sel:[0,0,1] op_sel_hi:[1,0,1]
    v_pk_fma_f32 v[118:119], v[118:119], v[102:103], v[102:103] op_sel:[0,0,1] op_sel_hi:[1,0,1]
    v_pk_fma_f32 v[120:121], v[120:121], v[104:105], v[104:105] op_sel:[0,0,1] op_sel_hi:[1,0,1]
    v_pk_fma_f32 v[122:123], v[122:123], v[106:107], v[106:107] op_sel:[0,0,1] op_sel_hi:[1,0,1]
    v_cvt_pk_bf16_f32 v194, v116, v117
    v_cvt_pk_bf16_f32 v198, v118, v119
    v_cvt_pk_bf16_f32 v202, v120, v121
    v_cvt_pk_bf16_f32 v206, v122, v123
    v_lshlrev_b32 v116, 16, v243
    v_lshlrev_b32 v118, 16, v247
    v_lshlrev_b32 v120, 16, v251
    v_lshlrev_b32 v122, 16, v255
    v_and_b32 v117, 0xffff0000, v243
    v_and_b32 v119, 0xffff0000, v247
    v_and_b32 v121, 0xffff0000, v251
    v_and_b32 v123, 0xffff0000, v255
    v_pk_fma_f32 v[116:117], v[116:117], v[214:215], v[222:223] neg_lo:[0,0,1] neg_hi:[0,0,1]
    v_pk_fma_f32 v[118:119], v[118:119], v[214:215], v[222:223] neg_lo:[0,0,1] neg_hi:[0,0,1]
    v_pk_fma_f32 v[120:121], v[120:121], v[214:215], v[222:223] neg_lo:[0,0,1] neg_hi:[0,0,1]
    v_pk_fma_f32 v[122:123], v[122:123], v[214:215], v[222:223] neg_lo:[0,0,1] neg_hi:[0,0,1]
    v_cvt_pk_bf16_f32 v116, v116, v117
    v_cvt_pk_bf16_f32 v118, v118, v119
    v_cvt_pk_bf16_f32 v120, v120, v121
    v_cvt_pk_bf16_f32 v122, v122, v123
    v_and_b32 v117, 0xffff0000, v116
    v_and_b32 v119, 0xffff0000, v118
    v_and_b32 v121, 0xffff0000, v120
    v_and_b32 v123, 0xffff0000, v122
    v_lshlrev_b32 v116, 16, v116
    v_lshlrev_b32 v118, 16, v118
    v_lshlrev_b32 v120, 16, v120
    v_lshlrev_b32 v122, 16, v122
    v_pk_fma_f32 v[116:117], v[116:117], v[100:101], v[100:101] op_sel:[0,0,1] op_sel_hi:[1,0,1]
    v_pk_fma_f32 v[118:119], v[118:119], v[102:103], v[102:103] op_sel:[0,0,1] op_sel_hi:[1,0,1]
    v_pk_fma_f32 v[120:121], v[120:121], v[104:105], v[104:105] op_sel:[0,0,1] op_sel_hi:[1,0,1]
    v_pk_fma_f32 v[122:123], v[122:123], v[106:107], v[106:107] op_sel:[0,0,1] op_sel_hi:[1,0,1]
    v_cvt_pk_bf16_f32 v195, v116, v117
    v_cvt_pk_bf16_f32 v199, v118, v119
    v_cvt_pk_bf16_f32 v203, v120, v121
    v_cvt_pk_bf16_f32 v207, v122, v123
    v_lshlrev_b32 v9, 4, v0
    v_add_u32 v10, 16384, v9
    ds_write_b128 v10, v[192:195]
    v_add_u32 v10, 36864, v9
    ds_write_b128 v10, v[196:199]
    v_add_u32 v10, 57344, v9
    ds_write_b128 v10, v[200:203]
    v_add_u32 v10, 77824, v9
    ds_write_b128 v10, v[204:207]
    v_and_b32 v5, 15, v1
    v_lshrrev_b32 v6, 4, v1
    v_lshrrev_b32 v9, 2, v5
    v_and_b32 v10, 3, v5
    v_sub_u32 v10, 3, v10
    v_mul_u32_u24 v10, 4096, v10
    v_lshlrev_b32 v9, 3, v9
    v_lshlrev_b32 v11, 4, v6
    v_sub_u32 v11, v11, v9
    v_add_u32 v10, v10, v11
    v_add_u32 v10, 24, v10
    v_add_u32 v2, s33, v10
    v_cmp_gt_i32 vcc, 40, v11
    v_cndmask_b32 v12, 0, -1, vcc
    v_cmp_gt_i32 vcc, 32, v11
    v_cndmask_b32 v13, 0, -1, vcc
    v_lshlrev_b32 v9, 5, v5
    v_lshl_add_u32 v9, v6, 4, v9
    s_add_u32 s38, s33, 15904
    v_add_u32 v3, s38, v9
    s_waitcnt lgkmcnt(0)
    s_barrier
    ds_read_b128 v[96:99], v3 offset:448
    ds_read_b64 v[64:65], v2 offset:4032
    ds_read_b64 v[66:67], v2 offset:4040
    ds_read_b128 v[100:103], v3 offset:960
    ds_read_b64 v[68:69], v2 offset:3520
    ds_read_b64 v[70:71], v2 offset:3528
    ds_read_b128 v[104:107], v3 offset:1472
    ds_read_b64 v[72:73], v2 offset:3008
    ds_read_b64 v[74:75], v2 offset:3016
    ds_read_b128 v[108:111], v3 offset:1984
    ds_read_b64 v[76:77], v2 offset:2496
    ds_read_b64 v[78:79], v2 offset:2504
    s_waitcnt lgkmcnt(0)
    ds_read_b128 v[112:115], v3 offset:2496
    ds_read_b64 v[80:81], v2 offset:1984
    ds_read_b64 v[82:83], v2 offset:1992
    ds_read_b128 v[116:119], v3 offset:3008
    ds_read_b64 v[84:85], v2 offset:1472
    ds_read_b64 v[86:87], v2 offset:1480
    ds_read_b128 v[120:123], v3 offset:3520
    ds_read_b64 v[88:89], v2 offset:960
    ds_read_b64 v[90:91], v2 offset:968
    ds_read_b128 v[124:127], v3 offset:4032
    ds_read_b64 v[92:93], v2 offset:448
    ds_read_b64 v[94:95], v2 offset:456
    s_waitcnt lgkmcnt(0)
    v_and_b32 v64, v64, v12
    v_and_b32 v65, v65, v12
    v_and_b32 v66, v66, v13
    v_and_b32 v67, v67, v13
    v_cmp_le_u32 vcc, 32, v9
    v_cndmask_b32 v96, 0, v96, vcc
    v_cndmask_b32 v97, 0, v97, vcc
    v_cndmask_b32 v98, 0, v98, vcc
    v_cndmask_b32 v99, 0, v99, vcc
    s_nop 1
    v_mfma_f32_16x16x32_bf16 v[36:39], v[64:67], v[100:103], 0
    v_mfma_f32_16x16x32_bf16 v[40:43], v[64:67], v[104:107], 0
    v_mfma_f32_16x16x32_bf16 v[44:47], v[64:67], v[108:111], 0
    v_mfma_f32_16x16x32_bf16 v[48:51], v[64:67], v[112:115], 0
    v_mfma_f32_16x16x32_bf16 v[52:55], v[64:67], v[116:119], 0
    v_mfma_f32_16x16x32_bf16 v[56:59], v[64:67], v[120:123], 0
    v_mfma_f32_16x16x32_bf16 v[60:63], v[64:67], v[124:127], 0
    ds_read_b128 v[160:163], v3 offset:384
    v_mfma_f32_16x16x32_bf16 v[40:43], v[68:71], v[100:103], v[40:43]
    ds_read_b64 v[128:129], v2 offset:3968
    v_mfma_f32_16x16x32_bf16 v[44:47], v[68:71], v[104:107], v[44:47]
    ds_read_b64 v[130:131], v2 offset:3976
    v_mfma_f32_16x16x32_bf16 v[48:51], v[68:71], v[108:111], v[48:51]
    ds_read_b128 v[164:167], v3 offset:896
    v_mfma_f32_16x16x32_bf16 v[52:55], v[68:71], v[112:115], v[52:55]
    ds_read_b64 v[132:133], v2 offset:3456
    v_mfma_f32_16x16x32_bf16 v[56:59], v[68:71], v[116:119], v[56:59]
    ds_read_b64 v[134:135], v2 offset:3464
    v_mfma_f32_16x16x32_bf16 v[60:63], v[68:71], v[120:123], v[60:63]
    ds_read_b128 v[168:171], v3 offset:1408
    v_mfma_f32_16x16x32_bf16 v[44:47], v[72:75], v[100:103], v[44:47]
    ds_read_b64 v[136:137], v2 offset:2944
    v_mfma_f32_16x16x32_bf16 v[48:51], v[72:75], v[104:107], v[48:51]
    ds_read_b64 v[138:139], v2 offset:2952
    v_mfma_f32_16x16x32_bf16 v[52:55], v[72:75], v[108:111], v[52:55]
    ds_read_b128 v[172:175], v3 offset:1920
    v_mfma_f32_16x16x32_bf16 v[56:59], v[72:75], v[112:115], v[56:59]
    ds_read_b64 v[140:141], v2 offset:2432
    v_mfma_f32_16x16x32_bf16 v[60:63], v[72:75], v[116:119], v[60:63]
    ds_read_b64 v[142:143], v2 offset:2440
    v_mfma_f32_16x16x32_bf16 v[48:51], v[76:79], v[100:103], v[48:51]
    ds_read_b128 v[176:179], v3 offset:2432
    v_mfma_f32_16x16x32_bf16 v[52:55], v[76:79], v[104:107], v[52:55]
    ds_read_b64 v[144:145], v2 offset:1920
    v_mfma_f32_16x16x32_bf16 v[56:59], v[76:79], v[108:111], v[56:59]
    ds_read_b64 v[146:147], v2 offset:1928
    v_mfma_f32_16x16x32_bf16 v[60:63], v[76:79], v[112:115], v[60:63]
    ds_read_b128 v[180:183], v3 offset:2944
    v_mfma_f32_16x16x32_bf16 v[52:55], v[80:83], v[100:103], v[52:55]
    ds_read_b64 v[148:149], v2 offset:1408
    v_mfma_f32_16x16x32_bf16 v[56:59], v[80:83], v[104:107], v[56:59]
    ds_read_b64 v[150:151], v2 offset:1416
    v_mfma_f32_16x16x32_bf16 v[60:63], v[80:83], v[108:111], v[60:63]
    ds_read_b128 v[184:187], v3 offset:3456
    v_mfma_f32_16x16x32_bf16 v[56:59], v[84:87], v[100:103], v[56:59]
    ds_read_b64 v[152:153], v2 offset:896
    v_mfma_f32_16x16x32_bf16 v[60:63], v[84:87], v[104:107], v[60:63]
    ds_read_b64 v[154:155], v2 offset:904
    v_mfma_f32_16x16x32_bf16 v[60:63], v[88:91], v[100:103], v[60:63]
    ds_read_b128 v[188:191], v3 offset:3968
    v_mfma_f32_16x16x32_bf16 v[32:35], v[64:67], v[96:99], 0
    ds_read_b64 v[156:157], v2 offset:384
    v_mfma_f32_16x16x32_bf16 v[36:39], v[68:71], v[96:99], v[36:39]
    ds_read_b64 v[158:159], v2 offset:392
    v_mfma_f32_16x16x32_bf16 v[40:43], v[72:75], v[96:99], v[40:43]
    v_mfma_f32_16x16x32_bf16 v[44:47], v[76:79], v[96:99], v[44:47]
    v_mfma_f32_16x16x32_bf16 v[48:51], v[80:83], v[96:99], v[48:51]
    v_mfma_f32_16x16x32_bf16 v[52:55], v[84:87], v[96:99], v[52:55]
    v_mfma_f32_16x16x32_bf16 v[56:59], v[88:91], v[96:99], v[56:59]
    v_mfma_f32_16x16x32_bf16 v[60:63], v[92:95], v[96:99], v[60:63]
    s_waitcnt lgkmcnt(0)
    s_mov_b32 s64, 96
    v_mfma_f32_16x16x32_bf16 v[36:39], v[128:131], v[164:167], v[36:39]
    v_cmp_le_u32 vcc, s64, v9
    v_mfma_f32_16x16x32_bf16 v[40:43], v[128:131], v[168:171], v[40:43]
    v_cndmask_b32 v160, 0, v160, vcc
    v_mfma_f32_16x16x32_bf16 v[44:47], v[128:131], v[172:175], v[44:47]
    v_cndmask_b32 v161, 0, v161, vcc
    v_mfma_f32_16x16x32_bf16 v[48:51], v[128:131], v[176:179], v[48:51]
    v_cndmask_b32 v162, 0, v162, vcc
    v_mfma_f32_16x16x32_bf16 v[52:55], v[128:131], v[180:183], v[52:55]
    v_cndmask_b32 v163, 0, v163, vcc
    v_mfma_f32_16x16x32_bf16 v[56:59], v[128:131], v[184:187], v[56:59]
    v_mfma_f32_16x16x32_bf16 v[60:63], v[128:131], v[188:191], v[60:63]
    ds_read_b128 v[96:99], v3 offset:320
    v_mfma_f32_16x16x32_bf16 v[40:43], v[132:135], v[164:167], v[40:43]
    ds_read_b64 v[64:65], v2 offset:3904
    v_mfma_f32_16x16x32_bf16 v[44:47], v[132:135], v[168:171], v[44:47]
    ds_read_b64 v[66:67], v2 offset:3912
    v_mfma_f32_16x16x32_bf16 v[48:51], v[132:135], v[172:175], v[48:51]
    ds_read_b128 v[100:103], v3 offset:832
    v_mfma_f32_16x16x32_bf16 v[52:55], v[132:135], v[176:179], v[52:55]
    ds_read_b64 v[68:69], v2 offset:3392
    v_mfma_f32_16x16x32_bf16 v[56:59], v[132:135], v[180:183], v[56:59]
    ds_read_b64 v[70:71], v2 offset:3400
    v_mfma_f32_16x16x32_bf16 v[60:63], v[132:135], v[184:187], v[60:63]
    ds_read_b128 v[104:107], v3 offset:1344
    v_mfma_f32_16x16x32_bf16 v[44:47], v[136:139], v[164:167], v[44:47]
    ds_read_b64 v[72:73], v2 offset:2880
    v_mfma_f32_16x16x32_bf16 v[48:51], v[136:139], v[168:171], v[48:51]
    ds_read_b64 v[74:75], v2 offset:2888
    v_mfma_f32_16x16x32_bf16 v[52:55], v[136:139], v[172:175], v[52:55]
    ds_read_b128 v[108:111], v3 offset:1856
    v_mfma_f32_16x16x32_bf16 v[56:59], v[136:139], v[176:179], v[56:59]
    ds_read_b64 v[76:77], v2 offset:2368
    v_mfma_f32_16x16x32_bf16 v[60:63], v[136:139], v[180:183], v[60:63]
    ds_read_b64 v[78:79], v2 offset:2376
    v_mfma_f32_16x16x32_bf16 v[48:51], v[140:143], v[164:167], v[48:51]
    ds_read_b128 v[112:115], v3 offset:2368
    v_mfma_f32_16x16x32_bf16 v[52:55], v[140:143], v[168:171], v[52:55]
    ds_read_b64 v[80:81], v2 offset:1856
    v_mfma_f32_16x16x32_bf16 v[56:59], v[140:143], v[172:175], v[56:59]
    ds_read_b64 v[82:83], v2 offset:1864
    v_mfma_f32_16x16x32_bf16 v[60:63], v[140:143], v[176:179], v[60:63]
    ds_read_b128 v[116:119], v3 offset:2880
    v_mfma_f32_16x16x32_bf16 v[52:55], v[144:147], v[164:167], v[52:55]
    ds_read_b64 v[84:85], v2 offset:1344
    v_mfma_f32_16x16x32_bf16 v[56:59], v[144:147], v[168:171], v[56:59]
    ds_read_b64 v[86:87], v2 offset:1352
    v_mfma_f32_16x16x32_bf16 v[60:63], v[144:147], v[172:175], v[60:63]
    ds_read_b128 v[120:123], v3 offset:3392
    v_mfma_f32_16x16x32_bf16 v[56:59], v[148:151], v[164:167], v[56:59]
    ds_read_b64 v[88:89], v2 offset:832
    v_mfma_f32_16x16x32_bf16 v[60:63], v[148:151], v[168:171], v[60:63]
    ds_read_b64 v[90:91], v2 offset:840
    v_mfma_f32_16x16x32_bf16 v[60:63], v[152:155], v[164:167], v[60:63]
    ds_read_b128 v[124:127], v3 offset:3904
    v_mfma_f32_16x16x32_bf16 v[32:35], v[128:131], v[160:163], v[32:35]
    ds_read_b64 v[92:93], v2 offset:320
    v_mfma_f32_16x16x32_bf16 v[36:39], v[132:135], v[160:163], v[36:39]
    ds_read_b64 v[94:95], v2 offset:328
    v_mfma_f32_16x16x32_bf16 v[40:43], v[136:139], v[160:163], v[40:43]
    v_mfma_f32_16x16x32_bf16 v[44:47], v[140:143], v[160:163], v[44:47]
    v_mfma_f32_16x16x32_bf16 v[48:51], v[144:147], v[160:163], v[48:51]
    v_mfma_f32_16x16x32_bf16 v[52:55], v[148:151], v[160:163], v[52:55]
    v_mfma_f32_16x16x32_bf16 v[56:59], v[152:155], v[160:163], v[56:59]
    v_mfma_f32_16x16x32_bf16 v[60:63], v[156:159], v[160:163], v[60:63]
    s_waitcnt lgkmcnt(0)
    s_mov_b32 s64, 160
    v_mfma_f32_16x16x32_bf16 v[36:39], v[64:67], v[100:103], v[36:39]
    v_cmp_le_u32 vcc, s64, v9
    v_mfma_f32_16x16x32_bf16 v[40:43], v[64:67], v[104:107], v[40:43]
    v_cndmask_b32 v96, 0, v96, vcc
    v_mfma_f32_16x16x32_bf16 v[44:47], v[64:67], v[108:111], v[44:47]
    v_cndmask_b32 v97, 0, v97, vcc
    v_mfma_f32_16x16x32_bf16 v[48:51], v[64:67], v[112:115], v[48:51]
    v_cndmask_b32 v98, 0, v98, vcc
    v_mfma_f32_16x16x32_bf16 v[52:55], v[64:67], v[116:119], v[52:55]
    v_cndmask_b32 v99, 0, v99, vcc
    v_mfma_f32_16x16x32_bf16 v[56:59], v[64:67], v[120:123], v[56:59]
    v_mfma_f32_16x16x32_bf16 v[60:63], v[64:67], v[124:127], v[60:63]
    ds_read_b128 v[160:163], v3 offset:256
    v_mfma_f32_16x16x32_bf16 v[40:43], v[68:71], v[100:103], v[40:43]
    ds_read_b64 v[128:129], v2 offset:3840
    v_mfma_f32_16x16x32_bf16 v[44:47], v[68:71], v[104:107], v[44:47]
    ds_read_b64 v[130:131], v2 offset:3848
    v_mfma_f32_16x16x32_bf16 v[48:51], v[68:71], v[108:111], v[48:51]
    ds_read_b128 v[164:167], v3 offset:768
    v_mfma_f32_16x16x32_bf16 v[52:55], v[68:71], v[112:115], v[52:55]
    ds_read_b64 v[132:133], v2 offset:3328
    v_mfma_f32_16x16x32_bf16 v[56:59], v[68:71], v[116:119], v[56:59]
    ds_read_b64 v[134:135], v2 offset:3336
    v_mfma_f32_16x16x32_bf16 v[60:63], v[68:71], v[120:123], v[60:63]
    ds_read_b128 v[168:171], v3 offset:1280
    v_mfma_f32_16x16x32_bf16 v[44:47], v[72:75], v[100:103], v[44:47]
    ds_read_b64 v[136:137], v2 offset:2816
    v_mfma_f32_16x16x32_bf16 v[48:51], v[72:75], v[104:107], v[48:51]
    ds_read_b64 v[138:139], v2 offset:2824
    v_mfma_f32_16x16x32_bf16 v[52:55], v[72:75], v[108:111], v[52:55]
    ds_read_b128 v[172:175], v3 offset:1792
    v_mfma_f32_16x16x32_bf16 v[56:59], v[72:75], v[112:115], v[56:59]
    ds_read_b64 v[140:141], v2 offset:2304
    v_mfma_f32_16x16x32_bf16 v[60:63], v[72:75], v[116:119], v[60:63]
    ds_read_b64 v[142:143], v2 offset:2312
    v_mfma_f32_16x16x32_bf16 v[48:51], v[76:79], v[100:103], v[48:51]
    ds_read_b128 v[176:179], v3 offset:2304
    v_mfma_f32_16x16x32_bf16 v[52:55], v[76:79], v[104:107], v[52:55]
    ds_read_b64 v[144:145], v2 offset:1792
    v_mfma_f32_16x16x32_bf16 v[56:59], v[76:79], v[108:111], v[56:59]
    ds_read_b64 v[146:147], v2 offset:1800
    v_mfma_f32_16x16x32_bf16 v[60:63], v[76:79], v[112:115], v[60:63]
    ds_read_b128 v[180:183], v3 offset:2816
    v_mfma_f32_16x16x32_bf16 v[52:55], v[80:83], v[100:103], v[52:55]
    ds_read_b64 v[148:149], v2 offset:1280
    v_mfma_f32_16x16x32_bf16 v[56:59], v[80:83], v[104:107], v[56:59]
    ds_read_b64 v[150:151], v2 offset:1288
    v_mfma_f32_16x16x32_bf16 v[60:63], v[80:83], v[108:111], v[60:63]
    ds_read_b128 v[184:187], v3 offset:3328
    v_mfma_f32_16x16x32_bf16 v[56:59], v[84:87], v[100:103], v[56:59]
    ds_read_b64 v[152:153], v2 offset:768
    v_mfma_f32_16x16x32_bf16 v[60:63], v[84:87], v[104:107], v[60:63]
    ds_read_b64 v[154:155], v2 offset:776
    v_mfma_f32_16x16x32_bf16 v[60:63], v[88:91], v[100:103], v[60:63]
    ds_read_b128 v[188:191], v3 offset:3840
    v_mfma_f32_16x16x32_bf16 v[32:35], v[64:67], v[96:99], v[32:35]
    ds_read_b64 v[156:157], v2 offset:256
    v_mfma_f32_16x16x32_bf16 v[36:39], v[68:71], v[96:99], v[36:39]
    ds_read_b64 v[158:159], v2 offset:264
    v_mfma_f32_16x16x32_bf16 v[40:43], v[72:75], v[96:99], v[40:43]
    v_mfma_f32_16x16x32_bf16 v[44:47], v[76:79], v[96:99], v[44:47]
    v_mfma_f32_16x16x32_bf16 v[48:51], v[80:83], v[96:99], v[48:51]
    v_mfma_f32_16x16x32_bf16 v[52:55], v[84:87], v[96:99], v[52:55]
    v_mfma_f32_16x16x32_bf16 v[56:59], v[88:91], v[96:99], v[56:59]
    v_mfma_f32_16x16x32_bf16 v[60:63], v[92:95], v[96:99], v[60:63]
    s_waitcnt lgkmcnt(0)
    s_mov_b32 s64, 224
    v_mfma_f32_16x16x32_bf16 v[36:39], v[128:131], v[164:167], v[36:39]
    v_cmp_le_u32 vcc, s64, v9
    v_mfma_f32_16x16x32_bf16 v[40:43], v[128:131], v[168:171], v[40:43]
    v_cndmask_b32 v160, 0, v160, vcc
    v_mfma_f32_16x16x32_bf16 v[44:47], v[128:131], v[172:175], v[44:47]
    v_cndmask_b32 v161, 0, v161, vcc
    v_mfma_f32_16x16x32_bf16 v[48:51], v[128:131], v[176:179], v[48:51]
    v_cndmask_b32 v162, 0, v162, vcc
    v_mfma_f32_16x16x32_bf16 v[52:55], v[128:131], v[180:183], v[52:55]
    v_cndmask_b32 v163, 0, v163, vcc
    v_mfma_f32_16x16x32_bf16 v[56:59], v[128:131], v[184:187], v[56:59]
    v_mfma_f32_16x16x32_bf16 v[60:63], v[128:131], v[188:191], v[60:63]
    ds_read_b128 v[96:99], v3 offset:192
    v_mfma_f32_16x16x32_bf16 v[40:43], v[132:135], v[164:167], v[40:43]
    ds_read_b64 v[64:65], v2 offset:3776
    v_mfma_f32_16x16x32_bf16 v[44:47], v[132:135], v[168:171], v[44:47]
    ds_read_b64 v[66:67], v2 offset:3784
    v_mfma_f32_16x16x32_bf16 v[48:51], v[132:135], v[172:175], v[48:51]
    ds_read_b128 v[100:103], v3 offset:704
    v_mfma_f32_16x16x32_bf16 v[52:55], v[132:135], v[176:179], v[52:55]
    ds_read_b64 v[68:69], v2 offset:3264
    v_mfma_f32_16x16x32_bf16 v[56:59], v[132:135], v[180:183], v[56:59]
    ds_read_b64 v[70:71], v2 offset:3272
    v_mfma_f32_16x16x32_bf16 v[60:63], v[132:135], v[184:187], v[60:63]
    ds_read_b128 v[104:107], v3 offset:1216
    v_mfma_f32_16x16x32_bf16 v[44:47], v[136:139], v[164:167], v[44:47]
    ds_read_b64 v[72:73], v2 offset:2752
    v_mfma_f32_16x16x32_bf16 v[48:51], v[136:139], v[168:171], v[48:51]
    ds_read_b64 v[74:75], v2 offset:2760
    v_mfma_f32_16x16x32_bf16 v[52:55], v[136:139], v[172:175], v[52:55]
    ds_read_b128 v[108:111], v3 offset:1728
    v_mfma_f32_16x16x32_bf16 v[56:59], v[136:139], v[176:179], v[56:59]
    ds_read_b64 v[76:77], v2 offset:2240
    v_mfma_f32_16x16x32_bf16 v[60:63], v[136:139], v[180:183], v[60:63]
    ds_read_b64 v[78:79], v2 offset:2248
    v_mfma_f32_16x16x32_bf16 v[48:51], v[140:143], v[164:167], v[48:51]
    ds_read_b128 v[112:115], v3 offset:2240
    v_mfma_f32_16x16x32_bf16 v[52:55], v[140:143], v[168:171], v[52:55]
    ds_read_b64 v[80:81], v2 offset:1728
    v_mfma_f32_16x16x32_bf16 v[56:59], v[140:143], v[172:175], v[56:59]
    ds_read_b64 v[82:83], v2 offset:1736
    v_mfma_f32_16x16x32_bf16 v[60:63], v[140:143], v[176:179], v[60:63]
    ds_read_b128 v[116:119], v3 offset:2752
    v_mfma_f32_16x16x32_bf16 v[52:55], v[144:147], v[164:167], v[52:55]
    ds_read_b64 v[84:85], v2 offset:1216
    v_mfma_f32_16x16x32_bf16 v[56:59], v[144:147], v[168:171], v[56:59]
    ds_read_b64 v[86:87], v2 offset:1224
    v_mfma_f32_16x16x32_bf16 v[60:63], v[144:147], v[172:175], v[60:63]
    ds_read_b128 v[120:123], v3 offset:3264
    v_mfma_f32_16x16x32_bf16 v[56:59], v[148:151], v[164:167], v[56:59]
    ds_read_b64 v[88:89], v2 offset:704
    v_mfma_f32_16x16x32_bf16 v[60:63], v[148:151], v[168:171], v[60:63]
    ds_read_b64 v[90:91], v2 offset:712
    v_mfma_f32_16x16x32_bf16 v[60:63], v[152:155], v[164:167], v[60:63]
    ds_read_b128 v[124:127], v3 offset:3776
    v_mfma_f32_16x16x32_bf16 v[32:35], v[128:131], v[160:163], v[32:35]
    ds_read_b64 v[92:93], v2 offset:192
    v_mfma_f32_16x16x32_bf16 v[36:39], v[132:135], v[160:163], v[36:39]
    ds_read_b64 v[94:95], v2 offset:200
    v_mfma_f32_16x16x32_bf16 v[40:43], v[136:139], v[160:163], v[40:43]
    v_mfma_f32_16x16x32_bf16 v[44:47], v[140:143], v[160:163], v[44:47]
    v_mfma_f32_16x16x32_bf16 v[48:51], v[144:147], v[160:163], v[48:51]
    v_mfma_f32_16x16x32_bf16 v[52:55], v[148:151], v[160:163], v[52:55]
    v_mfma_f32_16x16x32_bf16 v[56:59], v[152:155], v[160:163], v[56:59]
    v_mfma_f32_16x16x32_bf16 v[60:63], v[156:159], v[160:163], v[60:63]
    s_waitcnt lgkmcnt(0)
    s_mov_b32 s64, 288
    v_mfma_f32_16x16x32_bf16 v[36:39], v[64:67], v[100:103], v[36:39]
    v_cmp_le_u32 vcc, s64, v9
    v_mfma_f32_16x16x32_bf16 v[40:43], v[64:67], v[104:107], v[40:43]
    v_cndmask_b32 v96, 0, v96, vcc
    v_mfma_f32_16x16x32_bf16 v[44:47], v[64:67], v[108:111], v[44:47]
    v_cndmask_b32 v97, 0, v97, vcc
    v_mfma_f32_16x16x32_bf16 v[48:51], v[64:67], v[112:115], v[48:51]
    v_cndmask_b32 v98, 0, v98, vcc
    v_mfma_f32_16x16x32_bf16 v[52:55], v[64:67], v[116:119], v[52:55]
    v_cndmask_b32 v99, 0, v99, vcc
    v_mfma_f32_16x16x32_bf16 v[56:59], v[64:67], v[120:123], v[56:59]
    v_mfma_f32_16x16x32_bf16 v[60:63], v[64:67], v[124:127], v[60:63]
    ds_read_b128 v[160:163], v3 offset:128
    v_mfma_f32_16x16x32_bf16 v[40:43], v[68:71], v[100:103], v[40:43]
    ds_read_b64 v[128:129], v2 offset:3712
    v_mfma_f32_16x16x32_bf16 v[44:47], v[68:71], v[104:107], v[44:47]
    ds_read_b64 v[130:131], v2 offset:3720
    v_mfma_f32_16x16x32_bf16 v[48:51], v[68:71], v[108:111], v[48:51]
    ds_read_b128 v[164:167], v3 offset:640
    v_mfma_f32_16x16x32_bf16 v[52:55], v[68:71], v[112:115], v[52:55]
    ds_read_b64 v[132:133], v2 offset:3200
    v_mfma_f32_16x16x32_bf16 v[56:59], v[68:71], v[116:119], v[56:59]
    ds_read_b64 v[134:135], v2 offset:3208
    v_mfma_f32_16x16x32_bf16 v[60:63], v[68:71], v[120:123], v[60:63]
    ds_read_b128 v[168:171], v3 offset:1152
    v_mfma_f32_16x16x32_bf16 v[44:47], v[72:75], v[100:103], v[44:47]
    ds_read_b64 v[136:137], v2 offset:2688
    v_mfma_f32_16x16x32_bf16 v[48:51], v[72:75], v[104:107], v[48:51]
    ds_read_b64 v[138:139], v2 offset:2696
    v_mfma_f32_16x16x32_bf16 v[52:55], v[72:75], v[108:111], v[52:55]
    ds_read_b128 v[172:175], v3 offset:1664
    v_mfma_f32_16x16x32_bf16 v[56:59], v[72:75], v[112:115], v[56:59]
    ds_read_b64 v[140:141], v2 offset:2176
    v_mfma_f32_16x16x32_bf16 v[60:63], v[72:75], v[116:119], v[60:63]
    ds_read_b64 v[142:143], v2 offset:2184
    v_mfma_f32_16x16x32_bf16 v[48:51], v[76:79], v[100:103], v[48:51]
    ds_read_b128 v[176:179], v3 offset:2176
    v_mfma_f32_16x16x32_bf16 v[52:55], v[76:79], v[104:107], v[52:55]
    ds_read_b64 v[144:145], v2 offset:1664
    v_mfma_f32_16x16x32_bf16 v[56:59], v[76:79], v[108:111], v[56:59]
    ds_read_b64 v[146:147], v2 offset:1672
    v_mfma_f32_16x16x32_bf16 v[60:63], v[76:79], v[112:115], v[60:63]
    ds_read_b128 v[180:183], v3 offset:2688
    v_mfma_f32_16x16x32_bf16 v[52:55], v[80:83], v[100:103], v[52:55]
    ds_read_b64 v[148:149], v2 offset:1152
    v_mfma_f32_16x16x32_bf16 v[56:59], v[80:83], v[104:107], v[56:59]
    ds_read_b64 v[150:151], v2 offset:1160
    v_mfma_f32_16x16x32_bf16 v[60:63], v[80:83], v[108:111], v[60:63]
    ds_read_b128 v[184:187], v3 offset:3200
    v_mfma_f32_16x16x32_bf16 v[56:59], v[84:87], v[100:103], v[56:59]
    ds_read_b64 v[152:153], v2 offset:640
    v_mfma_f32_16x16x32_bf16 v[60:63], v[84:87], v[104:107], v[60:63]
    ds_read_b64 v[154:155], v2 offset:648
    v_mfma_f32_16x16x32_bf16 v[60:63], v[88:91], v[100:103], v[60:63]
    ds_read_b128 v[188:191], v3 offset:3712
    v_mfma_f32_16x16x32_bf16 v[32:35], v[64:67], v[96:99], v[32:35]
    ds_read_b64 v[156:157], v2 offset:128
    v_mfma_f32_16x16x32_bf16 v[36:39], v[68:71], v[96:99], v[36:39]
    ds_read_b64 v[158:159], v2 offset:136
    v_mfma_f32_16x16x32_bf16 v[40:43], v[72:75], v[96:99], v[40:43]
    v_mfma_f32_16x16x32_bf16 v[44:47], v[76:79], v[96:99], v[44:47]
    v_mfma_f32_16x16x32_bf16 v[48:51], v[80:83], v[96:99], v[48:51]
    v_mfma_f32_16x16x32_bf16 v[52:55], v[84:87], v[96:99], v[52:55]
    v_mfma_f32_16x16x32_bf16 v[56:59], v[88:91], v[96:99], v[56:59]
    v_mfma_f32_16x16x32_bf16 v[60:63], v[92:95], v[96:99], v[60:63]
    s_waitcnt lgkmcnt(0)
    s_mov_b32 s64, 352
    v_mfma_f32_16x16x32_bf16 v[36:39], v[128:131], v[164:167], v[36:39]
    v_cmp_le_u32 vcc, s64, v9
    v_mfma_f32_16x16x32_bf16 v[40:43], v[128:131], v[168:171], v[40:43]
    v_cndmask_b32 v160, 0, v160, vcc
    v_mfma_f32_16x16x32_bf16 v[44:47], v[128:131], v[172:175], v[44:47]
    v_cndmask_b32 v161, 0, v161, vcc
    v_mfma_f32_16x16x32_bf16 v[48:51], v[128:131], v[176:179], v[48:51]
    v_cndmask_b32 v162, 0, v162, vcc
    v_mfma_f32_16x16x32_bf16 v[52:55], v[128:131], v[180:183], v[52:55]
    v_cndmask_b32 v163, 0, v163, vcc
    v_mfma_f32_16x16x32_bf16 v[56:59], v[128:131], v[184:187], v[56:59]
    v_mfma_f32_16x16x32_bf16 v[60:63], v[128:131], v[188:191], v[60:63]
    ds_read_b128 v[96:99], v3 offset:64
    v_mfma_f32_16x16x32_bf16 v[40:43], v[132:135], v[164:167], v[40:43]
    ds_read_b64 v[64:65], v2 offset:3648
    v_mfma_f32_16x16x32_bf16 v[44:47], v[132:135], v[168:171], v[44:47]
    ds_read_b64 v[66:67], v2 offset:3656
    v_mfma_f32_16x16x32_bf16 v[48:51], v[132:135], v[172:175], v[48:51]
    ds_read_b128 v[100:103], v3 offset:576
    v_mfma_f32_16x16x32_bf16 v[52:55], v[132:135], v[176:179], v[52:55]
    ds_read_b64 v[68:69], v2 offset:3136
    v_mfma_f32_16x16x32_bf16 v[56:59], v[132:135], v[180:183], v[56:59]
    ds_read_b64 v[70:71], v2 offset:3144
    v_mfma_f32_16x16x32_bf16 v[60:63], v[132:135], v[184:187], v[60:63]
    ds_read_b128 v[104:107], v3 offset:1088
    v_mfma_f32_16x16x32_bf16 v[44:47], v[136:139], v[164:167], v[44:47]
    ds_read_b64 v[72:73], v2 offset:2624
    v_mfma_f32_16x16x32_bf16 v[48:51], v[136:139], v[168:171], v[48:51]
    ds_read_b64 v[74:75], v2 offset:2632
    v_mfma_f32_16x16x32_bf16 v[52:55], v[136:139], v[172:175], v[52:55]
    ds_read_b128 v[108:111], v3 offset:1600
    v_mfma_f32_16x16x32_bf16 v[56:59], v[136:139], v[176:179], v[56:59]
    ds_read_b64 v[76:77], v2 offset:2112
    v_mfma_f32_16x16x32_bf16 v[60:63], v[136:139], v[180:183], v[60:63]
    ds_read_b64 v[78:79], v2 offset:2120
    v_mfma_f32_16x16x32_bf16 v[48:51], v[140:143], v[164:167], v[48:51]
    ds_read_b128 v[112:115], v3 offset:2112
    v_mfma_f32_16x16x32_bf16 v[52:55], v[140:143], v[168:171], v[52:55]
    ds_read_b64 v[80:81], v2 offset:1600
    v_mfma_f32_16x16x32_bf16 v[56:59], v[140:143], v[172:175], v[56:59]
    ds_read_b64 v[82:83], v2 offset:1608
    v_mfma_f32_16x16x32_bf16 v[60:63], v[140:143], v[176:179], v[60:63]
    ds_read_b128 v[116:119], v3 offset:2624
    v_mfma_f32_16x16x32_bf16 v[52:55], v[144:147], v[164:167], v[52:55]
    ds_read_b64 v[84:85], v2 offset:1088
    v_mfma_f32_16x16x32_bf16 v[56:59], v[144:147], v[168:171], v[56:59]
    ds_read_b64 v[86:87], v2 offset:1096
    v_mfma_f32_16x16x32_bf16 v[60:63], v[144:147], v[172:175], v[60:63]
    ds_read_b128 v[120:123], v3 offset:3136
    v_mfma_f32_16x16x32_bf16 v[56:59], v[148:151], v[164:167], v[56:59]
    ds_read_b64 v[88:89], v2 offset:576
    v_mfma_f32_16x16x32_bf16 v[60:63], v[148:151], v[168:171], v[60:63]
    ds_read_b64 v[90:91], v2 offset:584
    v_mfma_f32_16x16x32_bf16 v[60:63], v[152:155], v[164:167], v[60:63]
    ds_read_b128 v[124:127], v3 offset:3648
    v_mfma_f32_16x16x32_bf16 v[32:35], v[128:131], v[160:163], v[32:35]
    ds_read_b64 v[92:93], v2 offset:64
    v_mfma_f32_16x16x32_bf16 v[36:39], v[132:135], v[160:163], v[36:39]
    ds_read_b64 v[94:95], v2 offset:72
    v_mfma_f32_16x16x32_bf16 v[40:43], v[136:139], v[160:163], v[40:43]
    v_mfma_f32_16x16x32_bf16 v[44:47], v[140:143], v[160:163], v[44:47]
    v_mfma_f32_16x16x32_bf16 v[48:51], v[144:147], v[160:163], v[48:51]
    v_mfma_f32_16x16x32_bf16 v[52:55], v[148:151], v[160:163], v[52:55]
    v_mfma_f32_16x16x32_bf16 v[56:59], v[152:155], v[160:163], v[56:59]
    v_mfma_f32_16x16x32_bf16 v[60:63], v[156:159], v[160:163], v[60:63]
    s_waitcnt lgkmcnt(0)
    s_mov_b32 s64, 416
    v_mfma_f32_16x16x32_bf16 v[36:39], v[64:67], v[100:103], v[36:39]
    v_cmp_le_u32 vcc, s64, v9
    v_mfma_f32_16x16x32_bf16 v[40:43], v[64:67], v[104:107], v[40:43]
    v_cndmask_b32 v96, 0, v96, vcc
    v_mfma_f32_16x16x32_bf16 v[44:47], v[64:67], v[108:111], v[44:47]
    v_cndmask_b32 v97, 0, v97, vcc
    v_mfma_f32_16x16x32_bf16 v[48:51], v[64:67], v[112:115], v[48:51]
    v_cndmask_b32 v98, 0, v98, vcc
    v_mfma_f32_16x16x32_bf16 v[52:55], v[64:67], v[116:119], v[52:55]
    v_cndmask_b32 v99, 0, v99, vcc
    v_mfma_f32_16x16x32_bf16 v[56:59], v[64:67], v[120:123], v[56:59]
    v_mfma_f32_16x16x32_bf16 v[60:63], v[64:67], v[124:127], v[60:63]
    ds_read_b128 v[160:163], v3 offset:0
    v_mfma_f32_16x16x32_bf16 v[40:43], v[68:71], v[100:103], v[40:43]
    ds_read_b64 v[128:129], v2 offset:3584
    v_mfma_f32_16x16x32_bf16 v[44:47], v[68:71], v[104:107], v[44:47]
    ds_read_b64 v[130:131], v2 offset:3592
    v_mfma_f32_16x16x32_bf16 v[48:51], v[68:71], v[108:111], v[48:51]
    ds_read_b128 v[164:167], v3 offset:512
    v_mfma_f32_16x16x32_bf16 v[52:55], v[68:71], v[112:115], v[52:55]
    ds_read_b64 v[132:133], v2 offset:3072
    v_mfma_f32_16x16x32_bf16 v[56:59], v[68:71], v[116:119], v[56:59]
    ds_read_b64 v[134:135], v2 offset:3080
    v_mfma_f32_16x16x32_bf16 v[60:63], v[68:71], v[120:123], v[60:63]
    ds_read_b128 v[168:171], v3 offset:1024
    v_mfma_f32_16x16x32_bf16 v[44:47], v[72:75], v[100:103], v[44:47]
    ds_read_b64 v[136:137], v2 offset:2560
    v_mfma_f32_16x16x32_bf16 v[48:51], v[72:75], v[104:107], v[48:51]
    ds_read_b64 v[138:139], v2 offset:2568
    v_mfma_f32_16x16x32_bf16 v[52:55], v[72:75], v[108:111], v[52:55]
    ds_read_b128 v[172:175], v3 offset:1536
    v_mfma_f32_16x16x32_bf16 v[56:59], v[72:75], v[112:115], v[56:59]
    ds_read_b64 v[140:141], v2 offset:2048
    v_mfma_f32_16x16x32_bf16 v[60:63], v[72:75], v[116:119], v[60:63]
    ds_read_b64 v[142:143], v2 offset:2056
    v_mfma_f32_16x16x32_bf16 v[48:51], v[76:79], v[100:103], v[48:51]
    ds_read_b128 v[176:179], v3 offset:2048
    v_mfma_f32_16x16x32_bf16 v[52:55], v[76:79], v[104:107], v[52:55]
    ds_read_b64 v[144:145], v2 offset:1536
    v_mfma_f32_16x16x32_bf16 v[56:59], v[76:79], v[108:111], v[56:59]
    ds_read_b64 v[146:147], v2 offset:1544
    v_mfma_f32_16x16x32_bf16 v[60:63], v[76:79], v[112:115], v[60:63]
    ds_read_b128 v[180:183], v3 offset:2560
    v_mfma_f32_16x16x32_bf16 v[52:55], v[80:83], v[100:103], v[52:55]
    ds_read_b64 v[148:149], v2 offset:1024
    v_mfma_f32_16x16x32_bf16 v[56:59], v[80:83], v[104:107], v[56:59]
    ds_read_b64 v[150:151], v2 offset:1032
    v_mfma_f32_16x16x32_bf16 v[60:63], v[80:83], v[108:111], v[60:63]
    ds_read_b128 v[184:187], v3 offset:3072
    v_mfma_f32_16x16x32_bf16 v[56:59], v[84:87], v[100:103], v[56:59]
    ds_read_b64 v[152:153], v2 offset:512
    v_mfma_f32_16x16x32_bf16 v[60:63], v[84:87], v[104:107], v[60:63]
    ds_read_b64 v[154:155], v2 offset:520
    v_mfma_f32_16x16x32_bf16 v[60:63], v[88:91], v[100:103], v[60:63]
    ds_read_b128 v[188:191], v3 offset:3584
    v_mfma_f32_16x16x32_bf16 v[32:35], v[64:67], v[96:99], v[32:35]
    ds_read_b64 v[156:157], v2 offset:0
    v_mfma_f32_16x16x32_bf16 v[36:39], v[68:71], v[96:99], v[36:39]
    ds_read_b64 v[158:159], v2 offset:8
    v_mfma_f32_16x16x32_bf16 v[40:43], v[72:75], v[96:99], v[40:43]
    v_mfma_f32_16x16x32_bf16 v[44:47], v[76:79], v[96:99], v[44:47]
    v_mfma_f32_16x16x32_bf16 v[48:51], v[80:83], v[96:99], v[48:51]
    v_mfma_f32_16x16x32_bf16 v[52:55], v[84:87], v[96:99], v[52:55]
    v_mfma_f32_16x16x32_bf16 v[56:59], v[88:91], v[96:99], v[56:59]
    v_mfma_f32_16x16x32_bf16 v[60:63], v[92:95], v[96:99], v[60:63]
    s_waitcnt lgkmcnt(0)
    s_mov_b32 s64, 480
    v_mfma_f32_16x16x32_bf16 v[36:39], v[128:131], v[164:167], v[36:39]
    v_cmp_le_u32 vcc, s64, v9
    v_mfma_f32_16x16x32_bf16 v[40:43], v[128:131], v[168:171], v[40:43]
    v_cndmask_b32 v160, 0, v160, vcc
    v_mfma_f32_16x16x32_bf16 v[44:47], v[128:131], v[172:175], v[44:47]
    v_cndmask_b32 v161, 0, v161, vcc
    v_mfma_f32_16x16x32_bf16 v[48:51], v[128:131], v[176:179], v[48:51]
    v_cndmask_b32 v162, 0, v162, vcc
    v_mfma_f32_16x16x32_bf16 v[52:55], v[128:131], v[180:183], v[52:55]
    v_cndmask_b32 v163, 0, v163, vcc
    v_mfma_f32_16x16x32_bf16 v[56:59], v[128:131], v[184:187], v[56:59]
    v_mfma_f32_16x16x32_bf16 v[60:63], v[128:131], v[188:191], v[60:63]
    v_mfma_f32_16x16x32_bf16 v[40:43], v[132:135], v[164:167], v[40:43]
    v_mfma_f32_16x16x32_bf16 v[44:47], v[132:135], v[168:171], v[44:47]
    v_mfma_f32_16x16x32_bf16 v[48:51], v[132:135], v[172:175], v[48:51]
    v_mfma_f32_16x16x32_bf16 v[52:55], v[132:135], v[176:179], v[52:55]
    v_mfma_f32_16x16x32_bf16 v[56:59], v[132:135], v[180:183], v[56:59]
    v_mfma_f32_16x16x32_bf16 v[60:63], v[132:135], v[184:187], v[60:63]
    v_mfma_f32_16x16x32_bf16 v[44:47], v[136:139], v[164:167], v[44:47]
    v_mfma_f32_16x16x32_bf16 v[48:51], v[136:139], v[168:171], v[48:51]
    v_mfma_f32_16x16x32_bf16 v[52:55], v[136:139], v[172:175], v[52:55]
    v_mfma_f32_16x16x32_bf16 v[56:59], v[136:139], v[176:179], v[56:59]
    v_mfma_f32_16x16x32_bf16 v[60:63], v[136:139], v[180:183], v[60:63]
    v_mfma_f32_16x16x32_bf16 v[48:51], v[140:143], v[164:167], v[48:51]
    v_mfma_f32_16x16x32_bf16 v[52:55], v[140:143], v[168:171], v[52:55]
    v_mfma_f32_16x16x32_bf16 v[56:59], v[140:143], v[172:175], v[56:59]
    v_mfma_f32_16x16x32_bf16 v[60:63], v[140:143], v[176:179], v[60:63]
    v_mfma_f32_16x16x32_bf16 v[52:55], v[144:147], v[164:167], v[52:55]
    v_mfma_f32_16x16x32_bf16 v[56:59], v[144:147], v[168:171], v[56:59]
    v_mfma_f32_16x16x32_bf16 v[60:63], v[144:147], v[172:175], v[60:63]
    v_mfma_f32_16x16x32_bf16 v[56:59], v[148:151], v[164:167], v[56:59]
    v_mfma_f32_16x16x32_bf16 v[60:63], v[148:151], v[168:171], v[60:63]
    v_mfma_f32_16x16x32_bf16 v[60:63], v[152:155], v[164:167], v[60:63]
    v_mfma_f32_16x16x32_bf16 v[32:35], v[128:131], v[160:163], v[32:35]
    v_mfma_f32_16x16x32_bf16 v[36:39], v[132:135], v[160:163], v[36:39]
    v_mfma_f32_16x16x32_bf16 v[40:43], v[136:139], v[160:163], v[40:43]
    v_mfma_f32_16x16x32_bf16 v[44:47], v[140:143], v[160:163], v[44:47]
    v_mfma_f32_16x16x32_bf16 v[48:51], v[144:147], v[160:163], v[48:51]
    v_mfma_f32_16x16x32_bf16 v[52:55], v[148:151], v[160:163], v[52:55]
    v_mfma_f32_16x16x32_bf16 v[56:59], v[152:155], v[160:163], v[56:59]
    v_mfma_f32_16x16x32_bf16 v[60:63], v[156:159], v[160:163], v[60:63]
    v_lshlrev_b32 v4, 6, v5
    v_lshl_add_u32 v4, v6, 4, v4
    v_add_u32 v4, s33, v4
    v_lshlrev_b32 v7, 5, v0
    v_lshrrev_b32 v9, 4, v0
    v_mul_u32_u24 v9, 0xa000, v9
    v_lshlrev_b32 v9, 2, v9
    v_and_b32 v10, 15, v0
    v_lshl_add_u32 v9, v10, 4, v9
    s_lshl_b32 s46, s37, 10
    s_nop 7
    ds_write_b128 v4, v[32:35] offset:0
    ds_write_b128 v4, v[36:39] offset:1024
    ds_write_b128 v4, v[40:43] offset:2048
    ds_write_b128 v4, v[44:47] offset:3072
    ds_write_b128 v4, v[48:51] offset:4096
    ds_write_b128 v4, v[52:55] offset:5120
    ds_write_b128 v4, v[56:59] offset:6144
    ds_write_b128 v4, v[60:63] offset:7168
    s_waitcnt lgkmcnt(0)
    s_barrier
    v_add_u32 v10, 0, v7
    ds_read_b128 v[64:67], v10
    ds_read_b128 v[68:71], v10 offset:16
    v_add_u32 v10, 20480, v7
    ds_read_b128 v[72:75], v10
    ds_read_b128 v[76:79], v10 offset:16
    v_add_u32 v10, 40960, v7
    ds_read_b128 v[80:83], v10
    ds_read_b128 v[84:87], v10 offset:16
    v_add_u32 v10, 61440, v7
    ds_read_b128 v[88:91], v10
    ds_read_b128 v[92:95], v10 offset:16
    s_waitcnt lgkmcnt(6)
    v_lshlrev_b32 v116, 16, v192
    v_lshlrev_b32 v120, 16, v193
    v_lshlrev_b32 v124, 16, v194
    v_lshlrev_b32 v128, 16, v195
    v_and_b32 v117, 0xffff0000, v192
    v_and_b32 v121, 0xffff0000, v193
    v_and_b32 v125, 0xffff0000, v194
    v_and_b32 v129, 0xffff0000, v195
    v_lshlrev_b32 v118, 16, v240
    v_lshlrev_b32 v122, 16, v241
    v_lshlrev_b32 v126, 16, v242
    v_lshlrev_b32 v130, 16, v243
    v_and_b32 v119, 0xffff0000, v240
    v_and_b32 v123, 0xffff0000, v241
    v_and_b32 v127, 0xffff0000, v242
    v_and_b32 v131, 0xffff0000, v243
    v_pk_fma_f32 v[116:117], v[116:117], v[20:21], v[64:65] op_sel:[0,0,0] op_sel_hi:[1,0,1]
    v_pk_fma_f32 v[120:121], v[120:121], v[20:21], v[66:67] op_sel:[0,0,0] op_sel_hi:[1,0,1]
    v_pk_fma_f32 v[124:125], v[124:125], v[20:21], v[68:69] op_sel:[0,0,0] op_sel_hi:[1,0,1]
    v_pk_fma_f32 v[128:129], v[128:129], v[20:21], v[70:71] op_sel:[0,0,0] op_sel_hi:[1,0,1]
    v_pk_fma_f32 v[116:117], v[116:117], v[20:21], v[118:119] op_sel:[0,1,0] op_sel_hi:[1,1,1]
    v_pk_fma_f32 v[120:121], v[120:121], v[20:21], v[122:123] op_sel:[0,1,0] op_sel_hi:[1,1,1]
    v_pk_fma_f32 v[124:125], v[124:125], v[20:21], v[126:127] op_sel:[0,1,0] op_sel_hi:[1,1,1]
    v_pk_fma_f32 v[128:129], v[128:129], v[20:21], v[130:131] op_sel:[0,1,0] op_sel_hi:[1,1,1]
    v_cvt_pk_bf16_f32 v100, v116, v117
    v_cvt_pk_bf16_f32 v101, v120, v121
    v_cvt_pk_bf16_f32 v102, v124, v125
    v_cvt_pk_bf16_f32 v103, v128, v129
    buffer_store_dwordx4 v[100:103], v9, s[56:59], s46 offen offset:0 sc1
    s_waitcnt lgkmcnt(4)
    v_lshlrev_b32 v116, 16, v196
    v_lshlrev_b32 v120, 16, v197
    v_lshlrev_b32 v124, 16, v198
    v_lshlrev_b32 v128, 16, v199
    v_and_b32 v117, 0xffff0000, v196
    v_and_b32 v121, 0xffff0000, v197
    v_and_b32 v125, 0xffff0000, v198
    v_and_b32 v129, 0xffff0000, v199
    v_lshlrev_b32 v118, 16, v244
    v_lshlrev_b32 v122, 16, v245
    v_lshlrev_b32 v126, 16, v246
    v_lshlrev_b32 v130, 16, v247
    v_and_b32 v119, 0xffff0000, v244
    v_and_b32 v123, 0xffff0000, v245
    v_and_b32 v127, 0xffff0000, v246
    v_and_b32 v131, 0xffff0000, v247
    v_pk_fma_f32 v[116:117], v[116:117], v[22:23], v[72:73] op_sel:[0,0,0] op_sel_hi:[1,0,1]
    v_pk_fma_f32 v[120:121], v[120:121], v[22:23], v[74:75] op_sel:[0,0,0] op_sel_hi:[1,0,1]
    v_pk_fma_f32 v[124:125], v[124:125], v[22:23], v[76:77] op_sel:[0,0,0] op_sel_hi:[1,0,1]
    v_pk_fma_f32 v[128:129], v[128:129], v[22:23], v[78:79] op_sel:[0,0,0] op_sel_hi:[1,0,1]
    v_pk_fma_f32 v[116:117], v[116:117], v[22:23], v[118:119] op_sel:[0,1,0] op_sel_hi:[1,1,1]
    v_pk_fma_f32 v[120:121], v[120:121], v[22:23], v[122:123] op_sel:[0,1,0] op_sel_hi:[1,1,1]
    v_pk_fma_f32 v[124:125], v[124:125], v[22:23], v[126:127] op_sel:[0,1,0] op_sel_hi:[1,1,1]
    v_pk_fma_f32 v[128:129], v[128:129], v[22:23], v[130:131] op_sel:[0,1,0] op_sel_hi:[1,1,1]
    v_cvt_pk_bf16_f32 v104, v116, v117
    v_cvt_pk_bf16_f32 v105, v120, v121
    v_cvt_pk_bf16_f32 v106, v124, v125
    v_cvt_pk_bf16_f32 v107, v128, v129
    buffer_store_dwordx4 v[104:107], v9, s[56:59], s46 offen offset:256 sc1
    s_waitcnt lgkmcnt(2)
    v_lshlrev_b32 v116, 16, v200
    v_lshlrev_b32 v120, 16, v201
    v_lshlrev_b32 v124, 16, v202
    v_lshlrev_b32 v128, 16, v203
    v_and_b32 v117, 0xffff0000, v200
    v_and_b32 v121, 0xffff0000, v201
    v_and_b32 v125, 0xffff0000, v202
    v_and_b32 v129, 0xffff0000, v203
    v_lshlrev_b32 v118, 16, v248
    v_lshlrev_b32 v122, 16, v249
    v_lshlrev_b32 v126, 16, v250
    v_lshlrev_b32 v130, 16, v251
    v_and_b32 v119, 0xffff0000, v248
    v_and_b32 v123, 0xffff0000, v249
    v_and_b32 v127, 0xffff0000, v250
    v_and_b32 v131, 0xffff0000, v251
    v_pk_fma_f32 v[116:117], v[116:117], v[24:25], v[80:81] op_sel:[0,0,0] op_sel_hi:[1,0,1]
    v_pk_fma_f32 v[120:121], v[120:121], v[24:25], v[82:83] op_sel:[0,0,0] op_sel_hi:[1,0,1]
    v_pk_fma_f32 v[124:125], v[124:125], v[24:25], v[84:85] op_sel:[0,0,0] op_sel_hi:[1,0,1]
    v_pk_fma_f32 v[128:129], v[128:129], v[24:25], v[86:87] op_sel:[0,0,0] op_sel_hi:[1,0,1]
    v_pk_fma_f32 v[116:117], v[116:117], v[24:25], v[118:119] op_sel:[0,1,0] op_sel_hi:[1,1,1]
    v_pk_fma_f32 v[120:121], v[120:121], v[24:25], v[122:123] op_sel:[0,1,0] op_sel_hi:[1,1,1]
    v_pk_fma_f32 v[124:125], v[124:125], v[24:25], v[126:127] op_sel:[0,1,0] op_sel_hi:[1,1,1]
    v_pk_fma_f32 v[128:129], v[128:129], v[24:25], v[130:131] op_sel:[0,1,0] op_sel_hi:[1,1,1]
    v_cvt_pk_bf16_f32 v108, v116, v117
    v_cvt_pk_bf16_f32 v109, v120, v121
    v_cvt_pk_bf16_f32 v110, v124, v125
    v_cvt_pk_bf16_f32 v111, v128, v129
    buffer_store_dwordx4 v[108:111], v9, s[56:59], s46 offen offset:512 sc1
    s_waitcnt lgkmcnt(0)
    v_lshlrev_b32 v116, 16, v204
    v_lshlrev_b32 v120, 16, v205
    v_lshlrev_b32 v124, 16, v206
    v_lshlrev_b32 v128, 16, v207
    v_and_b32 v117, 0xffff0000, v204
    v_and_b32 v121, 0xffff0000, v205
    v_and_b32 v125, 0xffff0000, v206
    v_and_b32 v129, 0xffff0000, v207
    v_lshlrev_b32 v118, 16, v252
    v_lshlrev_b32 v122, 16, v253
    v_lshlrev_b32 v126, 16, v254
    v_lshlrev_b32 v130, 16, v255
    v_and_b32 v119, 0xffff0000, v252
    v_and_b32 v123, 0xffff0000, v253
    v_and_b32 v127, 0xffff0000, v254
    v_and_b32 v131, 0xffff0000, v255
    v_pk_fma_f32 v[116:117], v[116:117], v[26:27], v[88:89] op_sel:[0,0,0] op_sel_hi:[1,0,1]
    v_pk_fma_f32 v[120:121], v[120:121], v[26:27], v[90:91] op_sel:[0,0,0] op_sel_hi:[1,0,1]
    v_pk_fma_f32 v[124:125], v[124:125], v[26:27], v[92:93] op_sel:[0,0,0] op_sel_hi:[1,0,1]
    v_pk_fma_f32 v[128:129], v[128:129], v[26:27], v[94:95] op_sel:[0,0,0] op_sel_hi:[1,0,1]
    v_pk_fma_f32 v[116:117], v[116:117], v[26:27], v[118:119] op_sel:[0,1,0] op_sel_hi:[1,1,1]
    v_pk_fma_f32 v[120:121], v[120:121], v[26:27], v[122:123] op_sel:[0,1,0] op_sel_hi:[1,1,1]
    v_pk_fma_f32 v[124:125], v[124:125], v[26:27], v[126:127] op_sel:[0,1,0] op_sel_hi:[1,1,1]
    v_pk_fma_f32 v[128:129], v[128:129], v[26:27], v[130:131] op_sel:[0,1,0] op_sel_hi:[1,1,1]
    v_cvt_pk_bf16_f32 v112, v116, v117
    v_cvt_pk_bf16_f32 v113, v120, v121
    v_cvt_pk_bf16_f32 v114, v124, v125
    v_cvt_pk_bf16_f32 v115, v128, v129
    buffer_store_dwordx4 v[112:115], v9, s[56:59], s46 offen offset:768 sc1
    s_endpgm
K12_STATS:
    s_load_dwordx2 s[4:5], s[0:1], 0
    s_load_dwordx2 s[28:29], s[0:1], 120
    s_load_dwordx2 s[12:13], s[0:1], 112
    v_and_b32 v1, 63, v0
    v_lshrrev_b32 v2, 6, v0
    s_sub_u32 s3, s2, 220
    s_nop 0
    v_readfirstlane_b32 s30, v2
    s_mov_b32 s6, 2621440
    s_mov_b32 s7, 0x00020000
    s_mov_b32 s14, 256
    s_mov_b32 s15, 0x00020000
    v_lshrrev_b32 v3, 4, v1
    v_and_b32 v4, 15, v1
    v_mul_u32_u24 v5, 1280, v3
    v_lshl_add_u32 v5, v4, 4, v5
    s_lshl_b32 s31, s3, 6
    s_lshl_b32 s32, s30, 4
    s_add_u32 s31, s31, s32
    s_mul_i32 s32, s31, 1280
    s_waitcnt lgkmcnt(0)
    buffer_load_dwordx4 v[10:13], v5, s[4:7], s32 offen offset:0
    buffer_load_dwordx4 v[14:17], v5, s[4:7], s32 offen offset:256
    buffer_load_dwordx4 v[18:21], v5, s[4:7], s32 offen offset:512
    buffer_load_dwordx4 v[22:25], v5, s[4:7], s32 offen offset:768
    buffer_load_dwordx4 v[26:29], v5, s[4:7], s32 offen offset:1024
    s_add_u32 s32, s32, 5120
    buffer_load_dwordx4 v[30:33], v5, s[4:7], s32 offen offset:0
    buffer_load_dwordx4 v[34:37], v5, s[4:7], s32 offen offset:256
    buffer_load_dwordx4 v[38:41], v5, s[4:7], s32 offen offset:512
    buffer_load_dwordx4 v[42:45], v5, s[4:7], s32 offen offset:768
    buffer_load_dwordx4 v[46:49], v5, s[4:7], s32 offen offset:1024
    s_add_u32 s32, s32, 5120
    buffer_load_dwordx4 v[50:53], v5, s[4:7], s32 offen offset:0
    buffer_load_dwordx4 v[54:57], v5, s[4:7], s32 offen offset:256
    buffer_load_dwordx4 v[58:61], v5, s[4:7], s32 offen offset:512
    buffer_load_dwordx4 v[62:65], v5, s[4:7], s32 offen offset:768
    buffer_load_dwordx4 v[66:69], v5, s[4:7], s32 offen offset:1024
    s_add_u32 s32, s32, 5120
    buffer_load_dwordx4 v[70:73], v5, s[4:7], s32 offen offset:0
    buffer_load_dwordx4 v[74:77], v5, s[4:7], s32 offen offset:256
    buffer_load_dwordx4 v[78:81], v5, s[4:7], s32 offen offset:512
    buffer_load_dwordx4 v[82:85], v5, s[4:7], s32 offen offset:768
    buffer_load_dwordx4 v[86:89], v5, s[4:7], s32 offen offset:1024
    s_add_u32 s8, s28, 65536
    s_addc_u32 s9, s29, 0
    s_mov_b32 s10, 16384
    s_mov_b32 s11, 0x00020000
    s_mov_b32 s33, 0x3f803f80
    v_mov_b32 v96, 0
    v_mov_b32 v97, 0
    v_mov_b32 v98, 0
    v_mov_b32 v99, 0
    v_mov_b32 v100, 0
    v_mov_b32 v101, 0
    v_mov_b32 v102, 0
    v_mov_b32 v103, 0
    v_mov_b32 v104, 0
    v_mov_b32 v105, 0
    v_mov_b32 v106, 0
    v_mov_b32 v107, 0
    v_mov_b32 v108, 0
    v_mov_b32 v109, 0
    v_mov_b32 v110, 0
    v_mov_b32 v111, 0
    s_waitcnt vmcnt(19)
    v_dot2_f32_bf16 v96, v10, s33, v96
    v_dot2_f32_bf16 v104, v10, v10, v104
    v_dot2_f32_bf16 v97, v11, s33, v97
    v_dot2_f32_bf16 v105, v11, v11, v105
    v_dot2_f32_bf16 v96, v12, s33, v96
    v_dot2_f32_bf16 v104, v12, v12, v104
    v_dot2_f32_bf16 v97, v13, s33, v97
    v_dot2_f32_bf16 v105, v13, v13, v105
    s_waitcnt vmcnt(18)
    v_dot2_f32_bf16 v96, v14, s33, v96
    v_dot2_f32_bf16 v104, v14, v14, v104
    v_dot2_f32_bf16 v97, v15, s33, v97
    v_dot2_f32_bf16 v105, v15, v15, v105
    v_dot2_f32_bf16 v96, v16, s33, v96
    v_dot2_f32_bf16 v104, v16, v16, v104
    v_dot2_f32_bf16 v97, v17, s33, v97
    v_dot2_f32_bf16 v105, v17, v17, v105
    s_waitcnt vmcnt(17)
    v_dot2_f32_bf16 v96, v18, s33, v96
    v_dot2_f32_bf16 v104, v18, v18, v104
    v_dot2_f32_bf16 v97, v19, s33, v97
    v_dot2_f32_bf16 v105, v19, v19, v105
    v_dot2_f32_bf16 v96, v20, s33, v96
    v_dot2_f32_bf16 v104, v20, v20, v104
    v_dot2_f32_bf16 v97, v21, s33, v97
    v_dot2_f32_bf16 v105, v21, v21, v105
    s_waitcnt vmcnt(16)
    v_dot2_f32_bf16 v96, v22, s33, v96
    v_dot2_f32_bf16 v104, v22, v22, v104
    v_dot2_f32_bf16 v97, v23, s33, v97
    v_dot2_f32_bf16 v105, v23, v23, v105
    v_dot2_f32_bf16 v96, v24, s33, v96
    v_dot2_f32_bf16 v104, v24, v24, v104
    v_dot2_f32_bf16 v97, v25, s33, v97
    v_dot2_f32_bf16 v105, v25, v25, v105
    s_waitcnt vmcnt(15)
    v_dot2_f32_bf16 v96, v26, s33, v96
    v_dot2_f32_bf16 v104, v26, v26, v104
    v_dot2_f32_bf16 v97, v27, s33, v97
    v_dot2_f32_bf16 v105, v27, v27, v105
    v_dot2_f32_bf16 v96, v28, s33, v96
    v_dot2_f32_bf16 v104, v28, v28, v104
    v_dot2_f32_bf16 v97, v29, s33, v97
    v_dot2_f32_bf16 v105, v29, v29, v105
    s_waitcnt vmcnt(14)
    v_dot2_f32_bf16 v98, v30, s33, v98
    v_dot2_f32_bf16 v106, v30, v30, v106
    v_dot2_f32_bf16 v99, v31, s33, v99
    v_dot2_f32_bf16 v107, v31, v31, v107
    v_dot2_f32_bf16 v98, v32, s33, v98
    v_dot2_f32_bf16 v106, v32, v32, v106
    v_dot2_f32_bf16 v99, v33, s33, v99
    v_dot2_f32_bf16 v107, v33, v33, v107
    s_waitcnt vmcnt(13)
    v_dot2_f32_bf16 v98, v34, s33, v98
    v_dot2_f32_bf16 v106, v34, v34, v106
    v_dot2_f32_bf16 v99, v35, s33, v99
    v_dot2_f32_bf16 v107, v35, v35, v107
    v_dot2_f32_bf16 v98, v36, s33, v98
    v_dot2_f32_bf16 v106, v36, v36, v106
    v_dot2_f32_bf16 v99, v37, s33, v99
    v_dot2_f32_bf16 v107, v37, v37, v107
    s_waitcnt vmcnt(12)
    v_dot2_f32_bf16 v98, v38, s33, v98
    v_dot2_f32_bf16 v106, v38, v38, v106
    v_dot2_f32_bf16 v99, v39, s33, v99
    v_dot2_f32_bf16 v107, v39, v39, v107
    v_dot2_f32_bf16 v98, v40, s33, v98
    v_dot2_f32_bf16 v106, v40, v40, v106
    v_dot2_f32_bf16 v99, v41, s33, v99
    v_dot2_f32_bf16 v107, v41, v41, v107
    s_waitcnt vmcnt(11)
    v_dot2_f32_bf16 v98, v42, s33, v98
    v_dot2_f32_bf16 v106, v42, v42, v106
    v_dot2_f32_bf16 v99, v43, s33, v99
    v_dot2_f32_bf16 v107, v43, v43, v107
    v_dot2_f32_bf16 v98, v44, s33, v98
    v_dot2_f32_bf16 v106, v44, v44, v106
    v_dot2_f32_bf16 v99, v45, s33, v99
    v_dot2_f32_bf16 v107, v45, v45, v107
    s_waitcnt vmcnt(10)
    v_dot2_f32_bf16 v98, v46, s33, v98
    v_dot2_f32_bf16 v106, v46, v46, v106
    v_dot2_f32_bf16 v99, v47, s33, v99
    v_dot2_f32_bf16 v107, v47, v47, v107
    v_dot2_f32_bf16 v98, v48, s33, v98
    v_dot2_f32_bf16 v106, v48, v48, v106
    v_dot2_f32_bf16 v99, v49, s33, v99
    v_dot2_f32_bf16 v107, v49, v49, v107
    s_waitcnt vmcnt(9)
    v_dot2_f32_bf16 v100, v50, s33, v100
    v_dot2_f32_bf16 v108, v50, v50, v108
    v_dot2_f32_bf16 v101, v51, s33, v101
    v_dot2_f32_bf16 v109, v51, v51, v109
    v_dot2_f32_bf16 v100, v52, s33, v100
    v_dot2_f32_bf16 v108, v52, v52, v108
    v_dot2_f32_bf16 v101, v53, s33, v101
    v_dot2_f32_bf16 v109, v53, v53, v109
    s_waitcnt vmcnt(8)
    v_dot2_f32_bf16 v100, v54, s33, v100
    v_dot2_f32_bf16 v108, v54, v54, v108
    v_dot2_f32_bf16 v101, v55, s33, v101
    v_dot2_f32_bf16 v109, v55, v55, v109
    v_dot2_f32_bf16 v100, v56, s33, v100
    v_dot2_f32_bf16 v108, v56, v56, v108
    v_dot2_f32_bf16 v101, v57, s33, v101
    v_dot2_f32_bf16 v109, v57, v57, v109
    s_waitcnt vmcnt(7)
    v_dot2_f32_bf16 v100, v58, s33, v100
    v_dot2_f32_bf16 v108, v58, v58, v108
    v_dot2_f32_bf16 v101, v59, s33, v101
    v_dot2_f32_bf16 v109, v59, v59, v109
    v_dot2_f32_bf16 v100, v60, s33, v100
    v_dot2_f32_bf16 v108, v60, v60, v108
    v_dot2_f32_bf16 v101, v61, s33, v101
    v_dot2_f32_bf16 v109, v61, v61, v109
    s_waitcnt vmcnt(6)
    v_dot2_f32_bf16 v100, v62, s33, v100
    v_dot2_f32_bf16 v108, v62, v62, v108
    v_dot2_f32_bf16 v101, v63, s33, v101
    v_dot2_f32_bf16 v109, v63, v63, v109
    v_dot2_f32_bf16 v100, v64, s33, v100
    v_dot2_f32_bf16 v108, v64, v64, v108
    v_dot2_f32_bf16 v101, v65, s33, v101
    v_dot2_f32_bf16 v109, v65, v65, v109
    s_waitcnt vmcnt(5)
    v_dot2_f32_bf16 v100, v66, s33, v100
    v_dot2_f32_bf16 v108, v66, v66, v108
    v_dot2_f32_bf16 v101, v67, s33, v101
    v_dot2_f32_bf16 v109, v67, v67, v109
    v_dot2_f32_bf16 v100, v68, s33, v100
    v_dot2_f32_bf16 v108, v68, v68, v108
    v_dot2_f32_bf16 v101, v69, s33, v101
    v_dot2_f32_bf16 v109, v69, v69, v109
    s_waitcnt vmcnt(4)
    v_dot2_f32_bf16 v102, v70, s33, v102
    v_dot2_f32_bf16 v110, v70, v70, v110
    v_dot2_f32_bf16 v103, v71, s33, v103
    v_dot2_f32_bf16 v111, v71, v71, v111
    v_dot2_f32_bf16 v102, v72, s33, v102
    v_dot2_f32_bf16 v110, v72, v72, v110
    v_dot2_f32_bf16 v103, v73, s33, v103
    v_dot2_f32_bf16 v111, v73, v73, v111
    s_waitcnt vmcnt(3)
    v_dot2_f32_bf16 v102, v74, s33, v102
    v_dot2_f32_bf16 v110, v74, v74, v110
    v_dot2_f32_bf16 v103, v75, s33, v103
    v_dot2_f32_bf16 v111, v75, v75, v111
    v_dot2_f32_bf16 v102, v76, s33, v102
    v_dot2_f32_bf16 v110, v76, v76, v110
    v_dot2_f32_bf16 v103, v77, s33, v103
    v_dot2_f32_bf16 v111, v77, v77, v111
    s_waitcnt vmcnt(2)
    v_dot2_f32_bf16 v102, v78, s33, v102
    v_dot2_f32_bf16 v110, v78, v78, v110
    v_dot2_f32_bf16 v103, v79, s33, v103
    v_dot2_f32_bf16 v111, v79, v79, v111
    v_dot2_f32_bf16 v102, v80, s33, v102
    v_dot2_f32_bf16 v110, v80, v80, v110
    v_dot2_f32_bf16 v103, v81, s33, v103
    v_dot2_f32_bf16 v111, v81, v81, v111
    s_waitcnt vmcnt(1)
    v_dot2_f32_bf16 v102, v82, s33, v102
    v_dot2_f32_bf16 v110, v82, v82, v110
    v_dot2_f32_bf16 v103, v83, s33, v103
    v_dot2_f32_bf16 v111, v83, v83, v111
    v_dot2_f32_bf16 v102, v84, s33, v102
    v_dot2_f32_bf16 v110, v84, v84, v110
    v_dot2_f32_bf16 v103, v85, s33, v103
    v_dot2_f32_bf16 v111, v85, v85, v111
    s_waitcnt vmcnt(0)
    v_dot2_f32_bf16 v102, v86, s33, v102
    v_dot2_f32_bf16 v110, v86, v86, v110
    v_dot2_f32_bf16 v103, v87, s33, v103
    v_dot2_f32_bf16 v111, v87, v87, v111
    v_dot2_f32_bf16 v102, v88, s33, v102
    v_dot2_f32_bf16 v110, v88, v88, v110
    v_dot2_f32_bf16 v103, v89, s33, v103
    v_dot2_f32_bf16 v111, v89, v89, v111
    s_nop 1
    v_add_f32 v96, v96, v97
    v_add_f32 v104, v104, v105
    v_add_f32 v98, v98, v99
    v_add_f32 v106, v106, v107
    v_add_f32 v100, v100, v101
    v_add_f32 v108, v108, v109
    v_add_f32 v102, v102, v103
    v_add_f32 v110, v110, v111
    s_nop 1
    v_add_f32_dpp v96, v96, v96 row_shr:1 row_mask:0xf bank_mask:0xf bound_ctrl:0
    v_add_f32_dpp v98, v98, v98 row_shr:1 row_mask:0xf bank_mask:0xf bound_ctrl:0
    v_add_f32_dpp v100, v100, v100 row_shr:1 row_mask:0xf bank_mask:0xf bound_ctrl:0
    v_add_f32_dpp v102, v102, v102 row_shr:1 row_mask:0xf bank_mask:0xf bound_ctrl:0
    v_add_f32_dpp v104, v104, v104 row_shr:1 row_mask:0xf bank_mask:0xf bound_ctrl:0
    v_add_f32_dpp v106, v106, v106 row_shr:1 row_mask:0xf bank_mask:0xf bound_ctrl:0
    v_add_f32_dpp v108, v108, v108 row_shr:1 row_mask:0xf bank_mask:0xf bound_ctrl:0
    v_add_f32_dpp v110, v110, v110 row_shr:1 row_mask:0xf bank_mask:0xf bound_ctrl:0
    v_add_f32_dpp v96, v96, v96 row_shr:2 row_mask:0xf bank_mask:0xf bound_ctrl:0
    v_add_f32_dpp v98, v98, v98 row_shr:2 row_mask:0xf bank_mask:0xf bound_ctrl:0
    v_add_f32_dpp v100, v100, v100 row_shr:2 row_mask:0xf bank_mask:0xf bound_ctrl:0
    v_add_f32_dpp v102, v102, v102 row_shr:2 row_mask:0xf bank_mask:0xf bound_ctrl:0
    v_add_f32_dpp v104, v104, v104 row_shr:2 row_mask:0xf bank_mask:0xf bound_ctrl:0
    v_add_f32_dpp v106, v106, v106 row_shr:2 row_mask:0xf bank_mask:0xf bound_ctrl:0
    v_add_f32_dpp v108, v108, v108 row_shr:2 row_mask:0xf bank_mask:0xf bound_ctrl:0
    v_add_f32_dpp v110, v110, v110 row_shr:2 row_mask:0xf bank_mask:0xf bound_ctrl:0
    v_add_f32_dpp v96, v96, v96 row_shr:4 row_mask:0xf bank_mask:0xf bound_ctrl:0
    v_add_f32_dpp v98, v98, v98 row_shr:4 row_mask:0xf bank_mask:0xf bound_ctrl:0
    v_add_f32_dpp v100, v100, v100 row_shr:4 row_mask:0xf bank_mask:0xf bound_ctrl:0
    v_add_f32_dpp v102, v102, v102 row_shr:4 row_mask:0xf bank_mask:0xf bound_ctrl:0
    v_add_f32_dpp v104, v104, v104 row_shr:4 row_mask:0xf bank_mask:0xf bound_ctrl:0
    v_add_f32_dpp v106, v106, v106 row_shr:4 row_mask:0xf bank_mask:0xf bound_ctrl:0
    v_add_f32_dpp v108, v108, v108 row_shr:4 row_mask:0xf bank_mask:0xf bound_ctrl:0
    v_add_f32_dpp v110, v110, v110 row_shr:4 row_mask:0xf bank_mask:0xf bound_ctrl:0
    v_add_f32_dpp v96, v96, v96 row_shr:8 row_mask:0xf bank_mask:0xf bound_ctrl:0
    v_add_f32_dpp v98, v98, v98 row_shr:8 row_mask:0xf bank_mask:0xf bound_ctrl:0
    v_add_f32_dpp v100, v100, v100 row_shr:8 row_mask:0xf bank_mask:0xf bound_ctrl:0
    v_add_f32_dpp v102, v102, v102 row_shr:8 row_mask:0xf bank_mask:0xf bound_ctrl:0
    v_add_f32_dpp v104, v104, v104 row_shr:8 row_mask:0xf bank_mask:0xf bound_ctrl:0
    v_add_f32_dpp v106, v106, v106 row_shr:8 row_mask:0xf bank_mask:0xf bound_ctrl:0
    v_add_f32_dpp v108, v108, v108 row_shr:8 row_mask:0xf bank_mask:0xf bound_ctrl:0
    v_add_f32_dpp v110, v110, v110 row_shr:8 row_mask:0xf bank_mask:0xf bound_ctrl:0
    v_mul_f32 v96, 0x3acccccd, v96
    v_mul_f32 v98, 0x3acccccd, v98
    v_mul_f32 v100, 0x3acccccd, v100
    v_mul_f32 v102, 0x3acccccd, v102
    v_mul_f32 v104, 0x3acccccd, v104
    v_mul_f32 v106, 0x3acccccd, v106
    v_mul_f32 v108, 0x3acccccd, v108
    v_mul_f32 v110, 0x3acccccd, v110
    v_fma_f32 v104, -v96, v96, v104
    v_fma_f32 v106, -v98, v98, v106
    v_fma_f32 v108, -v100, v100, v108
    v_fma_f32 v110, -v102, v102, v110
    v_max_f32 v104, 0, v104
    v_max_f32 v106, 0, v106
    v_max_f32 v108, 0, v108
    v_max_f32 v110, 0, v110
    v_add_f32 v104, 0x3727c5ac, v104
    v_add_f32 v106, 0x3727c5ac, v106
    v_add_f32 v108, 0x3727c5ac, v108
    v_add_f32 v110, 0x3727c5ac, v110
    v_rsq_f32 v104, v104
    v_rsq_f32 v106, v106
    v_rsq_f32 v108, v108
    v_rsq_f32 v110, v110
    s_nop 0
    v_mul_f32 v96, v96, v104
    v_mul_f32 v98, v98, v106
    v_mul_f32 v100, v100, v108
    v_mul_f32 v102, v102, v110
    s_lshl_b32 s33, s30, 7
    v_lshl_add_u32 v6, v3, 2, s33
    s_mov_b32 s34, 0x80008000
    s_mov_b32 s35, 0x80008000
    s_mov_b64 exec, s[34:35]
    ds_write_b32 v6, v104 offset:0
    ds_write_b32 v6, v96 offset:32
    ds_write_b32 v6, v106 offset:16
    ds_write_b32 v6, v98 offset:48
    ds_write_b32 v6, v108 offset:64
    ds_write_b32 v6, v100 offset:96
    ds_write_b32 v6, v110 offset:80
    ds_write_b32 v6, v102 offset:112
    s_mov_b64 exec, 0xff
    s_waitcnt lgkmcnt(0)
    v_lshl_add_u32 v7, v1, 4, s33
    ds_read_b128 v[8:11], v7
    v_lshlrev_b32 v12, 4, v1
    s_lshl_b32 s36, s31, 3
    s_waitcnt lgkmcnt(0)
    buffer_store_dwordx4 v[8:11], v12, s[8:11], s36 offen sc1
    s_mov_b64 exec, -1
    s_waitcnt vmcnt(0)
    s_barrier
    s_cmp_lg_u32 s30, 0
    s_cbranch_scc1 K12_ST_END
    s_mov_b32 s40, 128
    v_mov_b32 v2, 0
    v_mov_b32 v3, 1
    s_mov_b64 exec, 1
    buffer_atomic_add v3, v2, s[12:15], 0 offen sc0 sc1
    s_waitcnt vmcnt(0)
    v_cmp_eq_u32 vcc, 61, v3
    v_mov_b32 v3, 1
    s_and_b64 exec, exec, vcc
    buffer_store_dword v3, v2, s[12:15], s40 offen sc1
    s_waitcnt vmcnt(0)
    s_mov_b64 exec, -1
K12_ST_END:
    s_endpgm
K12_GEMV:
    s_load_dwordx2 s[4:5], s[0:1], 96
    s_load_dwordx2 s[8:9], s[0:1], 88
    s_load_dwordx2 s[28:29], s[0:1], 120
    v_and_b32 v1, 63, v0
    v_lshrrev_b32 v2, 6, v0
    s_sub_u32 s3, s2, 160
    s_add_u32 s3, s3, 30
    s_cmp_ge_u32 s3, 60
    s_cselect_b32 s36, 60, 0
    s_sub_u32 s3, s3, s36
    s_load_dwordx2 s[16:17], s[0:1], 112
    s_nop 0
    v_readfirstlane_b32 s30, v2
    s_mov_b32 s6, 4915200
    s_mov_b32 s7, 0x00020000
    s_mov_b32 s10, 1280
    s_mov_b32 s11, 0x00020000
    v_lshrrev_b32 v3, 3, v1
    v_and_b32 v4, 7, v1
    v_mul_u32_u24 v5, 7680, v3
    v_lshl_add_u32 v5, v4, 4, v5
    s_lshl_b32 s31, s3, 7
    s_mul_i32 s32, s30, 1228800
    s_add_u32 s32, s32, s31
    v_lshlrev_b32 v6, 1, v0
    s_waitcnt lgkmcnt(0)
    buffer_load_ushort v100, v6, s[8:11], 0 offen offset:0
    buffer_load_ushort v101, v6, s[8:11], 0 offen offset:512
    buffer_load_ushort v102, v6, s[8:11], 0 offen offset:1024
    buffer_load_dwordx4 v[10:13], v5, s[4:7], s32 offen
    s_add_u32 s32, s32, 61440
    buffer_load_dwordx4 v[14:17], v5, s[4:7], s32 offen
    s_add_u32 s32, s32, 61440
    buffer_load_dwordx4 v[18:21], v5, s[4:7], s32 offen
    s_add_u32 s32, s32, 61440
    buffer_load_dwordx4 v[22:25], v5, s[4:7], s32 offen
    s_add_u32 s32, s32, 61440
    buffer_load_dwordx4 v[26:29], v5, s[4:7], s32 offen
    s_add_u32 s32, s32, 61440
    buffer_load_dwordx4 v[30:33], v5, s[4:7], s32 offen
    s_add_u32 s32, s32, 61440
    buffer_load_dwordx4 v[34:37], v5, s[4:7], s32 offen
    s_add_u32 s32, s32, 61440
    buffer_load_dwordx4 v[38:41], v5, s[4:7], s32 offen
    s_add_u32 s32, s32, 61440
    buffer_load_dwordx4 v[42:45], v5, s[4:7], s32 offen
    s_add_u32 s32, s32, 61440
    buffer_load_dwordx4 v[46:49], v5, s[4:7], s32 offen
    s_add_u32 s32, s32, 61440
    buffer_load_dwordx4 v[50:53], v5, s[4:7], s32 offen
    s_add_u32 s32, s32, 61440
    buffer_load_dwordx4 v[54:57], v5, s[4:7], s32 offen
    s_add_u32 s32, s32, 61440
    buffer_load_dwordx4 v[58:61], v5, s[4:7], s32 offen
    s_add_u32 s32, s32, 61440
    buffer_load_dwordx4 v[62:65], v5, s[4:7], s32 offen
    s_add_u32 s32, s32, 61440
    buffer_load_dwordx4 v[66:69], v5, s[4:7], s32 offen
    s_add_u32 s32, s32, 61440
    buffer_load_dwordx4 v[70:73], v5, s[4:7], s32 offen
    s_add_u32 s32, s32, 61440
    buffer_load_dwordx4 v[74:77], v5, s[4:7], s32 offen
    s_add_u32 s32, s32, 61440
    buffer_load_dwordx4 v[78:81], v5, s[4:7], s32 offen
    s_add_u32 s32, s32, 61440
    buffer_load_dwordx4 v[82:85], v5, s[4:7], s32 offen
    s_add_u32 s32, s32, 61440
    buffer_load_dwordx4 v[86:89], v5, s[4:7], s32 offen
    s_add_u32 s12, s28, 0
    s_addc_u32 s13, s29, 0
    s_mov_b32 s14, 15360
    s_mov_b32 s15, 0x00020000
    s_waitcnt vmcnt(20)
    v_lshlrev_b32 v100, 16, v100
    v_mul_f32 v103, 0xbfb8aa3b, v100
    v_lshlrev_b32 v101, 16, v101
    v_mul_f32 v104, 0xbfb8aa3b, v101
    v_lshlrev_b32 v102, 16, v102
    v_mul_f32 v105, 0xbfb8aa3b, v102
    v_exp_f32 v103, v103
    v_exp_f32 v104, v104
    v_exp_f32 v105, v105
    s_nop 0
    v_add_f32 v103, 1.0, v103
    v_add_f32 v104, 1.0, v104
    v_add_f32 v105, 1.0, v105
    v_rcp_f32 v103, v103
    v_rcp_f32 v104, v104
    v_rcp_f32 v105, v105
    s_nop 0
    v_mul_f32 v100, v100, v103
    v_mul_f32 v101, v101, v104
    v_mul_f32 v102, v102, v105
    v_cvt_pk_bf16_f32 v100, v100, v100
    v_cvt_pk_bf16_f32 v101, v101, v101
    v_cvt_pk_bf16_f32 v102, v102, v102
    v_lshlrev_b32 v100, 16, v100
    v_lshlrev_b32 v101, 16, v101
    v_lshlrev_b32 v102, 16, v102
    v_lshlrev_b32 v7, 2, v0
    ds_write_b32 v7, v100 offset:0
    ds_write_b32 v7, v101 offset:1024
    ds_write_b32 v7, v102 offset:2048
    s_waitcnt lgkmcnt(0)
    s_barrier
    s_mul_i32 s33, s30, 640
    v_lshl_add_u32 v7, v3, 2, s33
    ds_read_b32 v100, v7 offset:0
    ds_read_b32 v101, v7 offset:32
    ds_read_b32 v102, v7 offset:64
    ds_read_b32 v103, v7 offset:96
    ds_read_b32 v104, v7 offset:128
    ds_read_b32 v105, v7 offset:160
    ds_read_b32 v106, v7 offset:192
    ds_read_b32 v107, v7 offset:224
    ds_read_b32 v108, v7 offset:256
    ds_read_b32 v109, v7 offset:288
    s_waitcnt lgkmcnt(0)
    ds_read_b32 v110, v7 offset:320
    ds_read_b32 v111, v7 offset:352
    ds_read_b32 v112, v7 offset:384
    ds_read_b32 v113, v7 offset:416
    ds_read_b32 v114, v7 offset:448
    ds_read_b32 v115, v7 offset:480
    ds_read_b32 v116, v7 offset:512
    ds_read_b32 v117, v7 offset:544
    ds_read_b32 v118, v7 offset:576
    ds_read_b32 v119, v7 offset:608
    s_waitcnt lgkmcnt(0)
    s_waitcnt vmcnt(19)
    v_lshlrev_b32 v8, 16, v10
    v_and_b32 v9, 0xffff0000, v10
    v_mul_f32 v120, v8, v100
    v_mul_f32 v121, v9, v100
    v_lshlrev_b32 v8, 16, v11
    v_and_b32 v9, 0xffff0000, v11
    v_mul_f32 v122, v8, v100
    v_mul_f32 v123, v9, v100
    v_lshlrev_b32 v8, 16, v12
    v_and_b32 v9, 0xffff0000, v12
    v_mul_f32 v124, v8, v100
    v_mul_f32 v125, v9, v100
    v_lshlrev_b32 v8, 16, v13
    v_and_b32 v9, 0xffff0000, v13
    v_mul_f32 v126, v8, v100
    v_mul_f32 v127, v9, v100
    s_waitcnt vmcnt(18)
    v_lshlrev_b32 v8, 16, v14
    v_and_b32 v9, 0xffff0000, v14
    v_fma_f32 v120, v8, v101, v120
    v_fma_f32 v121, v9, v101, v121
    v_lshlrev_b32 v8, 16, v15
    v_and_b32 v9, 0xffff0000, v15
    v_fma_f32 v122, v8, v101, v122
    v_fma_f32 v123, v9, v101, v123
    v_lshlrev_b32 v8, 16, v16
    v_and_b32 v9, 0xffff0000, v16
    v_fma_f32 v124, v8, v101, v124
    v_fma_f32 v125, v9, v101, v125
    v_lshlrev_b32 v8, 16, v17
    v_and_b32 v9, 0xffff0000, v17
    v_fma_f32 v126, v8, v101, v126
    v_fma_f32 v127, v9, v101, v127
    s_waitcnt vmcnt(17)
    v_lshlrev_b32 v8, 16, v18
    v_and_b32 v9, 0xffff0000, v18
    v_fma_f32 v120, v8, v102, v120
    v_fma_f32 v121, v9, v102, v121
    v_lshlrev_b32 v8, 16, v19
    v_and_b32 v9, 0xffff0000, v19
    v_fma_f32 v122, v8, v102, v122
    v_fma_f32 v123, v9, v102, v123
    v_lshlrev_b32 v8, 16, v20
    v_and_b32 v9, 0xffff0000, v20
    v_fma_f32 v124, v8, v102, v124
    v_fma_f32 v125, v9, v102, v125
    v_lshlrev_b32 v8, 16, v21
    v_and_b32 v9, 0xffff0000, v21
    v_fma_f32 v126, v8, v102, v126
    v_fma_f32 v127, v9, v102, v127
    s_waitcnt vmcnt(16)
    v_lshlrev_b32 v8, 16, v22
    v_and_b32 v9, 0xffff0000, v22
    v_fma_f32 v120, v8, v103, v120
    v_fma_f32 v121, v9, v103, v121
    v_lshlrev_b32 v8, 16, v23
    v_and_b32 v9, 0xffff0000, v23
    v_fma_f32 v122, v8, v103, v122
    v_fma_f32 v123, v9, v103, v123
    v_lshlrev_b32 v8, 16, v24
    v_and_b32 v9, 0xffff0000, v24
    v_fma_f32 v124, v8, v103, v124
    v_fma_f32 v125, v9, v103, v125
    v_lshlrev_b32 v8, 16, v25
    v_and_b32 v9, 0xffff0000, v25
    v_fma_f32 v126, v8, v103, v126
    v_fma_f32 v127, v9, v103, v127
    s_waitcnt vmcnt(15)
    v_lshlrev_b32 v8, 16, v26
    v_and_b32 v9, 0xffff0000, v26
    v_fma_f32 v120, v8, v104, v120
    v_fma_f32 v121, v9, v104, v121
    v_lshlrev_b32 v8, 16, v27
    v_and_b32 v9, 0xffff0000, v27
    v_fma_f32 v122, v8, v104, v122
    v_fma_f32 v123, v9, v104, v123
    v_lshlrev_b32 v8, 16, v28
    v_and_b32 v9, 0xffff0000, v28
    v_fma_f32 v124, v8, v104, v124
    v_fma_f32 v125, v9, v104, v125
    v_lshlrev_b32 v8, 16, v29
    v_and_b32 v9, 0xffff0000, v29
    v_fma_f32 v126, v8, v104, v126
    v_fma_f32 v127, v9, v104, v127
    s_waitcnt vmcnt(14)
    v_lshlrev_b32 v8, 16, v30
    v_and_b32 v9, 0xffff0000, v30
    v_fma_f32 v120, v8, v105, v120
    v_fma_f32 v121, v9, v105, v121
    v_lshlrev_b32 v8, 16, v31
    v_and_b32 v9, 0xffff0000, v31
    v_fma_f32 v122, v8, v105, v122
    v_fma_f32 v123, v9, v105, v123
    v_lshlrev_b32 v8, 16, v32
    v_and_b32 v9, 0xffff0000, v32
    v_fma_f32 v124, v8, v105, v124
    v_fma_f32 v125, v9, v105, v125
    v_lshlrev_b32 v8, 16, v33
    v_and_b32 v9, 0xffff0000, v33
    v_fma_f32 v126, v8, v105, v126
    v_fma_f32 v127, v9, v105, v127
    s_waitcnt vmcnt(13)
    v_lshlrev_b32 v8, 16, v34
    v_and_b32 v9, 0xffff0000, v34
    v_fma_f32 v120, v8, v106, v120
    v_fma_f32 v121, v9, v106, v121
    v_lshlrev_b32 v8, 16, v35
    v_and_b32 v9, 0xffff0000, v35
    v_fma_f32 v122, v8, v106, v122
    v_fma_f32 v123, v9, v106, v123
    v_lshlrev_b32 v8, 16, v36
    v_and_b32 v9, 0xffff0000, v36
    v_fma_f32 v124, v8, v106, v124
    v_fma_f32 v125, v9, v106, v125
    v_lshlrev_b32 v8, 16, v37
    v_and_b32 v9, 0xffff0000, v37
    v_fma_f32 v126, v8, v106, v126
    v_fma_f32 v127, v9, v106, v127
    s_waitcnt vmcnt(12)
    v_lshlrev_b32 v8, 16, v38
    v_and_b32 v9, 0xffff0000, v38
    v_fma_f32 v120, v8, v107, v120
    v_fma_f32 v121, v9, v107, v121
    v_lshlrev_b32 v8, 16, v39
    v_and_b32 v9, 0xffff0000, v39
    v_fma_f32 v122, v8, v107, v122
    v_fma_f32 v123, v9, v107, v123
    v_lshlrev_b32 v8, 16, v40
    v_and_b32 v9, 0xffff0000, v40
    v_fma_f32 v124, v8, v107, v124
    v_fma_f32 v125, v9, v107, v125
    v_lshlrev_b32 v8, 16, v41
    v_and_b32 v9, 0xffff0000, v41
    v_fma_f32 v126, v8, v107, v126
    v_fma_f32 v127, v9, v107, v127
    s_waitcnt vmcnt(11)
    v_lshlrev_b32 v8, 16, v42
    v_and_b32 v9, 0xffff0000, v42
    v_fma_f32 v120, v8, v108, v120
    v_fma_f32 v121, v9, v108, v121
    v_lshlrev_b32 v8, 16, v43
    v_and_b32 v9, 0xffff0000, v43
    v_fma_f32 v122, v8, v108, v122
    v_fma_f32 v123, v9, v108, v123
    v_lshlrev_b32 v8, 16, v44
    v_and_b32 v9, 0xffff0000, v44
    v_fma_f32 v124, v8, v108, v124
    v_fma_f32 v125, v9, v108, v125
    v_lshlrev_b32 v8, 16, v45
    v_and_b32 v9, 0xffff0000, v45
    v_fma_f32 v126, v8, v108, v126
    v_fma_f32 v127, v9, v108, v127
    s_waitcnt vmcnt(10)
    v_lshlrev_b32 v8, 16, v46
    v_and_b32 v9, 0xffff0000, v46
    v_fma_f32 v120, v8, v109, v120
    v_fma_f32 v121, v9, v109, v121
    v_lshlrev_b32 v8, 16, v47
    v_and_b32 v9, 0xffff0000, v47
    v_fma_f32 v122, v8, v109, v122
    v_fma_f32 v123, v9, v109, v123
    v_lshlrev_b32 v8, 16, v48
    v_and_b32 v9, 0xffff0000, v48
    v_fma_f32 v124, v8, v109, v124
    v_fma_f32 v125, v9, v109, v125
    v_lshlrev_b32 v8, 16, v49
    v_and_b32 v9, 0xffff0000, v49
    v_fma_f32 v126, v8, v109, v126
    v_fma_f32 v127, v9, v109, v127
    s_waitcnt vmcnt(9)
    v_lshlrev_b32 v8, 16, v50
    v_and_b32 v9, 0xffff0000, v50
    v_fma_f32 v120, v8, v110, v120
    v_fma_f32 v121, v9, v110, v121
    v_lshlrev_b32 v8, 16, v51
    v_and_b32 v9, 0xffff0000, v51
    v_fma_f32 v122, v8, v110, v122
    v_fma_f32 v123, v9, v110, v123
    v_lshlrev_b32 v8, 16, v52
    v_and_b32 v9, 0xffff0000, v52
    v_fma_f32 v124, v8, v110, v124
    v_fma_f32 v125, v9, v110, v125
    v_lshlrev_b32 v8, 16, v53
    v_and_b32 v9, 0xffff0000, v53
    v_fma_f32 v126, v8, v110, v126
    v_fma_f32 v127, v9, v110, v127
    s_waitcnt vmcnt(8)
    v_lshlrev_b32 v8, 16, v54
    v_and_b32 v9, 0xffff0000, v54
    v_fma_f32 v120, v8, v111, v120
    v_fma_f32 v121, v9, v111, v121
    v_lshlrev_b32 v8, 16, v55
    v_and_b32 v9, 0xffff0000, v55
    v_fma_f32 v122, v8, v111, v122
    v_fma_f32 v123, v9, v111, v123
    v_lshlrev_b32 v8, 16, v56
    v_and_b32 v9, 0xffff0000, v56
    v_fma_f32 v124, v8, v111, v124
    v_fma_f32 v125, v9, v111, v125
    v_lshlrev_b32 v8, 16, v57
    v_and_b32 v9, 0xffff0000, v57
    v_fma_f32 v126, v8, v111, v126
    v_fma_f32 v127, v9, v111, v127
    s_waitcnt vmcnt(7)
    v_lshlrev_b32 v8, 16, v58
    v_and_b32 v9, 0xffff0000, v58
    v_fma_f32 v120, v8, v112, v120
    v_fma_f32 v121, v9, v112, v121
    v_lshlrev_b32 v8, 16, v59
    v_and_b32 v9, 0xffff0000, v59
    v_fma_f32 v122, v8, v112, v122
    v_fma_f32 v123, v9, v112, v123
    v_lshlrev_b32 v8, 16, v60
    v_and_b32 v9, 0xffff0000, v60
    v_fma_f32 v124, v8, v112, v124
    v_fma_f32 v125, v9, v112, v125
    v_lshlrev_b32 v8, 16, v61
    v_and_b32 v9, 0xffff0000, v61
    v_fma_f32 v126, v8, v112, v126
    v_fma_f32 v127, v9, v112, v127
    s_waitcnt vmcnt(6)
    v_lshlrev_b32 v8, 16, v62
    v_and_b32 v9, 0xffff0000, v62
    v_fma_f32 v120, v8, v113, v120
    v_fma_f32 v121, v9, v113, v121
    v_lshlrev_b32 v8, 16, v63
    v_and_b32 v9, 0xffff0000, v63
    v_fma_f32 v122, v8, v113, v122
    v_fma_f32 v123, v9, v113, v123
    v_lshlrev_b32 v8, 16, v64
    v_and_b32 v9, 0xffff0000, v64
    v_fma_f32 v124, v8, v113, v124
    v_fma_f32 v125, v9, v113, v125
    v_lshlrev_b32 v8, 16, v65
    v_and_b32 v9, 0xffff0000, v65
    v_fma_f32 v126, v8, v113, v126
    v_fma_f32 v127, v9, v113, v127
    s_waitcnt vmcnt(5)
    v_lshlrev_b32 v8, 16, v66
    v_and_b32 v9, 0xffff0000, v66
    v_fma_f32 v120, v8, v114, v120
    v_fma_f32 v121, v9, v114, v121
    v_lshlrev_b32 v8, 16, v67
    v_and_b32 v9, 0xffff0000, v67
    v_fma_f32 v122, v8, v114, v122
    v_fma_f32 v123, v9, v114, v123
    v_lshlrev_b32 v8, 16, v68
    v_and_b32 v9, 0xffff0000, v68
    v_fma_f32 v124, v8, v114, v124
    v_fma_f32 v125, v9, v114, v125
    v_lshlrev_b32 v8, 16, v69
    v_and_b32 v9, 0xffff0000, v69
    v_fma_f32 v126, v8, v114, v126
    v_fma_f32 v127, v9, v114, v127
    s_waitcnt vmcnt(4)
    v_lshlrev_b32 v8, 16, v70
    v_and_b32 v9, 0xffff0000, v70
    v_fma_f32 v120, v8, v115, v120
    v_fma_f32 v121, v9, v115, v121
    v_lshlrev_b32 v8, 16, v71
    v_and_b32 v9, 0xffff0000, v71
    v_fma_f32 v122, v8, v115, v122
    v_fma_f32 v123, v9, v115, v123
    v_lshlrev_b32 v8, 16, v72
    v_and_b32 v9, 0xffff0000, v72
    v_fma_f32 v124, v8, v115, v124
    v_fma_f32 v125, v9, v115, v125
    v_lshlrev_b32 v8, 16, v73
    v_and_b32 v9, 0xffff0000, v73
    v_fma_f32 v126, v8, v115, v126
    v_fma_f32 v127, v9, v115, v127
    s_waitcnt vmcnt(3)
    v_lshlrev_b32 v8, 16, v74
    v_and_b32 v9, 0xffff0000, v74
    v_fma_f32 v120, v8, v116, v120
    v_fma_f32 v121, v9, v116, v121
    v_lshlrev_b32 v8, 16, v75
    v_and_b32 v9, 0xffff0000, v75
    v_fma_f32 v122, v8, v116, v122
    v_fma_f32 v123, v9, v116, v123
    v_lshlrev_b32 v8, 16, v76
    v_and_b32 v9, 0xffff0000, v76
    v_fma_f32 v124, v8, v116, v124
    v_fma_f32 v125, v9, v116, v125
    v_lshlrev_b32 v8, 16, v77
    v_and_b32 v9, 0xffff0000, v77
    v_fma_f32 v126, v8, v116, v126
    v_fma_f32 v127, v9, v116, v127
    s_waitcnt vmcnt(2)
    v_lshlrev_b32 v8, 16, v78
    v_and_b32 v9, 0xffff0000, v78
    v_fma_f32 v120, v8, v117, v120
    v_fma_f32 v121, v9, v117, v121
    v_lshlrev_b32 v8, 16, v79
    v_and_b32 v9, 0xffff0000, v79
    v_fma_f32 v122, v8, v117, v122
    v_fma_f32 v123, v9, v117, v123
    v_lshlrev_b32 v8, 16, v80
    v_and_b32 v9, 0xffff0000, v80
    v_fma_f32 v124, v8, v117, v124
    v_fma_f32 v125, v9, v117, v125
    v_lshlrev_b32 v8, 16, v81
    v_and_b32 v9, 0xffff0000, v81
    v_fma_f32 v126, v8, v117, v126
    v_fma_f32 v127, v9, v117, v127
    s_waitcnt vmcnt(1)
    v_lshlrev_b32 v8, 16, v82
    v_and_b32 v9, 0xffff0000, v82
    v_fma_f32 v120, v8, v118, v120
    v_fma_f32 v121, v9, v118, v121
    v_lshlrev_b32 v8, 16, v83
    v_and_b32 v9, 0xffff0000, v83
    v_fma_f32 v122, v8, v118, v122
    v_fma_f32 v123, v9, v118, v123
    v_lshlrev_b32 v8, 16, v84
    v_and_b32 v9, 0xffff0000, v84
    v_fma_f32 v124, v8, v118, v124
    v_fma_f32 v125, v9, v118, v125
    v_lshlrev_b32 v8, 16, v85
    v_and_b32 v9, 0xffff0000, v85
    v_fma_f32 v126, v8, v118, v126
    v_fma_f32 v127, v9, v118, v127
    s_waitcnt vmcnt(0)
    v_lshlrev_b32 v8, 16, v86
    v_and_b32 v9, 0xffff0000, v86
    v_fma_f32 v120, v8, v119, v120
    v_fma_f32 v121, v9, v119, v121
    v_lshlrev_b32 v8, 16, v87
    v_and_b32 v9, 0xffff0000, v87
    v_fma_f32 v122, v8, v119, v122
    v_fma_f32 v123, v9, v119, v123
    v_lshlrev_b32 v8, 16, v88
    v_and_b32 v9, 0xffff0000, v88
    v_fma_f32 v124, v8, v119, v124
    v_fma_f32 v125, v9, v119, v125
    v_lshlrev_b32 v8, 16, v89
    v_and_b32 v9, 0xffff0000, v89
    v_fma_f32 v126, v8, v119, v126
    v_fma_f32 v127, v9, v119, v127
    s_lshl_b32 s33, s30, 11
    v_lshlrev_b32 v7, 8, v3
    v_lshl_add_u32 v7, v4, 5, v7
    v_add_u32 v7, s33, v7
    ds_write_b128 v7, v[120:123] offset:4096
    ds_write_b128 v7, v[124:127] offset:4112
    s_waitcnt lgkmcnt(0)
    s_barrier
    s_cmp_lg_u32 s30, 0
    s_cbranch_scc1 K12_GEMV_END
    v_lshlrev_b32 v7, 2, v1
    ds_read_b32 v10, v7 offset:4096
    ds_read_b32 v11, v7 offset:4352
    ds_read_b32 v12, v7 offset:4608
    ds_read_b32 v13, v7 offset:4864
    ds_read_b32 v14, v7 offset:5120
    ds_read_b32 v15, v7 offset:5376
    ds_read_b32 v16, v7 offset:5632
    ds_read_b32 v17, v7 offset:5888
    s_waitcnt lgkmcnt(0)
    ds_read_b32 v18, v7 offset:6144
    ds_read_b32 v19, v7 offset:6400
    ds_read_b32 v20, v7 offset:6656
    ds_read_b32 v21, v7 offset:6912
    ds_read_b32 v22, v7 offset:7168
    ds_read_b32 v23, v7 offset:7424
    ds_read_b32 v24, v7 offset:7680
    ds_read_b32 v25, v7 offset:7936
    s_waitcnt lgkmcnt(0)
    ds_read_b32 v26, v7 offset:8192
    ds_read_b32 v27, v7 offset:8448
    ds_read_b32 v28, v7 offset:8704
    ds_read_b32 v29, v7 offset:8960
    ds_read_b32 v30, v7 offset:9216
    ds_read_b32 v31, v7 offset:9472
    ds_read_b32 v32, v7 offset:9728
    ds_read_b32 v33, v7 offset:9984
    s_waitcnt lgkmcnt(0)
    ds_read_b32 v34, v7 offset:10240
    ds_read_b32 v35, v7 offset:10496
    ds_read_b32 v36, v7 offset:10752
    ds_read_b32 v37, v7 offset:11008
    ds_read_b32 v38, v7 offset:11264
    ds_read_b32 v39, v7 offset:11520
    ds_read_b32 v40, v7 offset:11776
    ds_read_b32 v41, v7 offset:12032
    s_waitcnt lgkmcnt(0)
    v_add_f32 v10, v10, v26
    v_add_f32 v11, v11, v27
    v_add_f32 v12, v12, v28
    v_add_f32 v13, v13, v29
    v_add_f32 v14, v14, v30
    v_add_f32 v15, v15, v31
    v_add_f32 v16, v16, v32
    v_add_f32 v17, v17, v33
    v_add_f32 v18, v18, v34
    v_add_f32 v19, v19, v35
    v_add_f32 v20, v20, v36
    v_add_f32 v21, v21, v37
    v_add_f32 v22, v22, v38
    v_add_f32 v23, v23, v39
    v_add_f32 v24, v24, v40
    v_add_f32 v25, v25, v41
    v_add_f32 v10, v10, v18
    v_add_f32 v11, v11, v19
    v_add_f32 v12, v12, v20
    v_add_f32 v13, v13, v21
    v_add_f32 v14, v14, v22
    v_add_f32 v15, v15, v23
    v_add_f32 v16, v16, v24
    v_add_f32 v17, v17, v25
    v_add_f32 v10, v10, v14
    v_add_f32 v11, v11, v15
    v_add_f32 v12, v12, v16
    v_add_f32 v13, v13, v17
    v_add_f32 v10, v10, v12
    v_add_f32 v11, v11, v13
    v_add_f32 v10, v10, v11
    v_cvt_pk_bf16_f32 v10, v10, v10
    v_lshlrev_b32 v10, 16, v10
    s_lshl_b32 s33, s3, 8
    buffer_store_dword v10, v7, s[12:15], s33 offen sc1
    s_waitcnt vmcnt(0)
    s_cmp_ge_u32 s3, 50
    s_cbranch_scc1 K12_GEMV_END
    s_mov_b32 s18, 256
    s_mov_b32 s19, 0x00020000
    s_cmp_ge_u32 s3, 30
    s_cselect_b32 s36, 4, 0
    s_add_u32 s37, s36, 128
    s_cmp_ge_u32 s3, 30
    s_cselect_b32 s38, 19, 61
    v_mov_b32 v2, 0
    v_mov_b32 v3, 1
    s_mov_b64 exec, 1
    buffer_atomic_add v3, v2, s[16:19], s36 offen sc0 sc1
    s_waitcnt vmcnt(0)
    v_cmp_eq_u32 vcc, s38, v3
    v_mov_b32 v3, 1
    s_and_b64 exec, exec, vcc
    buffer_store_dword v3, v2, s[16:19], s37 offen sc1
    s_waitcnt vmcnt(0)
    s_mov_b64 exec, -1
K12_GEMV_END:
    s_endpgm
K12_WD:
    s_load_dwordx2 s[4:5], s[0:1], 80
    s_load_dwordx2 s[28:29], s[0:1], 120
    v_and_b32 v1, 63, v0
    v_lshrrev_b32 v2, 6, v0
    s_sub_u32 s3, s2, 252
    s_nop 0
    v_readfirstlane_b32 s30, v2
    s_mov_b32 s6, 1966080
    s_mov_b32 s7, 0x00020000
    v_lshlrev_b32 v2, 2, v1
    s_lshl_b32 s31, s3, 5
    s_lshr_b32 s32, s30, 1
    s_lshl_b32 s32, s32, 4
    s_add_u32 s31, s31, s32
    s_and_b32 s32, s30, 1
    s_lshl_b32 s32, s32, 3
    s_add_u32 s31, s31, s32
    s_mul_i32 s32, s31, 1280
    s_waitcnt lgkmcnt(0)
    buffer_load_dword v10, v2, s[4:7], s32 offen offset:0
    buffer_load_dword v11, v2, s[4:7], s32 offen offset:256
    buffer_load_dword v12, v2, s[4:7], s32 offen offset:512
    buffer_load_dword v13, v2, s[4:7], s32 offen offset:768
    buffer_load_dword v14, v2, s[4:7], s32 offen offset:1024
    s_add_u32 s32, s32, 2560
    buffer_load_dword v15, v2, s[4:7], s32 offen offset:0
    buffer_load_dword v16, v2, s[4:7], s32 offen offset:256
    buffer_load_dword v17, v2, s[4:7], s32 offen offset:512
    buffer_load_dword v18, v2, s[4:7], s32 offen offset:768
    buffer_load_dword v19, v2, s[4:7], s32 offen offset:1024
    s_add_u32 s32, s32, 2560
    buffer_load_dword v20, v2, s[4:7], s32 offen offset:0
    buffer_load_dword v21, v2, s[4:7], s32 offen offset:256
    buffer_load_dword v22, v2, s[4:7], s32 offen offset:512
    buffer_load_dword v23, v2, s[4:7], s32 offen offset:768
    buffer_load_dword v24, v2, s[4:7], s32 offen offset:1024
    s_add_u32 s32, s32, 2560
    buffer_load_dword v25, v2, s[4:7], s32 offen offset:0
    buffer_load_dword v26, v2, s[4:7], s32 offen offset:256
    buffer_load_dword v27, v2, s[4:7], s32 offen offset:512
    buffer_load_dword v28, v2, s[4:7], s32 offen offset:768
    buffer_load_dword v29, v2, s[4:7], s32 offen offset:1024
    s_sub_u32 s32, s32, 6400
    buffer_load_dword v30, v2, s[4:7], s32 offen offset:0
    buffer_load_dword v31, v2, s[4:7], s32 offen offset:256
    buffer_load_dword v32, v2, s[4:7], s32 offen offset:512
    buffer_load_dword v33, v2, s[4:7], s32 offen offset:768
    buffer_load_dword v34, v2, s[4:7], s32 offen offset:1024
    s_add_u32 s32, s32, 2560
    buffer_load_dword v35, v2, s[4:7], s32 offen offset:0
    buffer_load_dword v36, v2, s[4:7], s32 offen offset:256
    buffer_load_dword v37, v2, s[4:7], s32 offen offset:512
    buffer_load_dword v38, v2, s[4:7], s32 offen offset:768
    buffer_load_dword v39, v2, s[4:7], s32 offen offset:1024
    s_add_u32 s32, s32, 2560
    buffer_load_dword v40, v2, s[4:7], s32 offen offset:0
    buffer_load_dword v41, v2, s[4:7], s32 offen offset:256
    buffer_load_dword v42, v2, s[4:7], s32 offen offset:512
    buffer_load_dword v43, v2, s[4:7], s32 offen offset:768
    buffer_load_dword v44, v2, s[4:7], s32 offen offset:1024
    s_add_u32 s32, s32, 2560
    buffer_load_dword v45, v2, s[4:7], s32 offen offset:0
    buffer_load_dword v46, v2, s[4:7], s32 offen offset:256
    buffer_load_dword v47, v2, s[4:7], s32 offen offset:512
    buffer_load_dword v48, v2, s[4:7], s32 offen offset:768
    buffer_load_dword v49, v2, s[4:7], s32 offen offset:1024
    s_add_u32 s8, s28, 14680064
    s_addc_u32 s9, s29, 0
    s_mov_b32 s10, 1966080
    s_mov_b32 s11, 0x00020000
    v_lshrrev_b32 v3, 3, v1
    v_and_b32 v4, 7, v1
    v_lshlrev_b32 v4, 5, v4
    v_add_u32 v5, 0, v3
    v_mul_u32_u24 v6, 205, v5
    v_lshrrev_b32 v6, 10, v6
    v_mul_u32_u24 v6, 240640, v6
    v_lshl_add_u32 v6, v5, 10, v6
    v_add_u32 v100, v6, v4
    v_add_u32 v5, 8, v3
    v_mul_u32_u24 v6, 205, v5
    v_lshrrev_b32 v6, 10, v6
    v_mul_u32_u24 v6, 240640, v6
    v_lshl_add_u32 v6, v5, 10, v6
    v_add_u32 v101, v6, v4
    v_add_u32 v5, 16, v3
    v_mul_u32_u24 v6, 205, v5
    v_lshrrev_b32 v6, 10, v6
    v_mul_u32_u24 v6, 240640, v6
    v_lshl_add_u32 v6, v5, 10, v6
    v_add_u32 v102, v6, v4
    v_add_u32 v5, 24, v3
    v_mul_u32_u24 v6, 205, v5
    v_lshrrev_b32 v6, 10, v6
    v_mul_u32_u24 v6, 240640, v6
    v_lshl_add_u32 v6, v5, 10, v6
    v_add_u32 v103, v6, v4
    v_add_u32 v5, 32, v3
    v_mul_u32_u24 v6, 205, v5
    v_lshrrev_b32 v6, 10, v6
    v_mul_u32_u24 v6, 240640, v6
    v_lshl_add_u32 v6, v5, 10, v6
    v_add_u32 v104, v6, v4
    s_mul_i32 s33, s3, 5120
    s_lshl_b32 s34, s30, 8
    s_add_u32 s33, s33, s34
    s_mov_b32 s35, 0x05040100
    s_mov_b32 s36, 0x07060302
    s_waitcnt vmcnt(0)
    v_perm_b32 v60, v15, v10, s35
    v_perm_b32 v64, v15, v10, s36
    v_perm_b32 v61, v25, v20, s35
    v_perm_b32 v65, v25, v20, s36
    v_perm_b32 v62, v35, v30, s35
    v_perm_b32 v66, v35, v30, s36
    v_perm_b32 v63, v45, v40, s35
    v_perm_b32 v67, v45, v40, s36
    buffer_store_dwordx4 v[60:63], v100, s[8:11], s33 offen
    buffer_store_dwordx4 v[64:67], v100, s[8:11], s33 offen offset:16
    v_perm_b32 v68, v16, v11, s35
    v_perm_b32 v72, v16, v11, s36
    v_perm_b32 v69, v26, v21, s35
    v_perm_b32 v73, v26, v21, s36
    v_perm_b32 v70, v36, v31, s35
    v_perm_b32 v74, v36, v31, s36
    v_perm_b32 v71, v46, v41, s35
    v_perm_b32 v75, v46, v41, s36
    buffer_store_dwordx4 v[68:71], v101, s[8:11], s33 offen
    buffer_store_dwordx4 v[72:75], v101, s[8:11], s33 offen offset:16
    v_perm_b32 v76, v17, v12, s35
    v_perm_b32 v80, v17, v12, s36
    v_perm_b32 v77, v27, v22, s35
    v_perm_b32 v81, v27, v22, s36
    v_perm_b32 v78, v37, v32, s35
    v_perm_b32 v82, v37, v32, s36
    v_perm_b32 v79, v47, v42, s35
    v_perm_b32 v83, v47, v42, s36
    buffer_store_dwordx4 v[76:79], v102, s[8:11], s33 offen
    buffer_store_dwordx4 v[80:83], v102, s[8:11], s33 offen offset:16
    v_perm_b32 v84, v18, v13, s35
    v_perm_b32 v88, v18, v13, s36
    v_perm_b32 v85, v28, v23, s35
    v_perm_b32 v89, v28, v23, s36
    v_perm_b32 v86, v38, v33, s35
    v_perm_b32 v90, v38, v33, s36
    v_perm_b32 v87, v48, v43, s35
    v_perm_b32 v91, v48, v43, s36
    buffer_store_dwordx4 v[84:87], v103, s[8:11], s33 offen
    buffer_store_dwordx4 v[88:91], v103, s[8:11], s33 offen offset:16
    v_perm_b32 v92, v19, v14, s35
    v_perm_b32 v96, v19, v14, s36
    v_perm_b32 v93, v29, v24, s35
    v_perm_b32 v97, v29, v24, s36
    v_perm_b32 v94, v39, v34, s35
    v_perm_b32 v98, v39, v34, s36
    v_perm_b32 v95, v49, v44, s35
    v_perm_b32 v99, v49, v44, s36
    buffer_store_dwordx4 v[92:95], v104, s[8:11], s33 offen
    buffer_store_dwordx4 v[96:99], v104, s[8:11], s33 offen offset:16
    s_endpgm
K12_WPREP:
    s_load_dwordx2 s[4:5], s[0:1], 64
    s_load_dwordx2 s[8:9], s[0:1], 72
    s_load_dwordx2 s[28:29], s[0:1], 120
    v_and_b32 v1, 63, v0
    v_lshrrev_b32 v2, 6, v0
    s_sub_u32 s3, s2, 300
    s_load_dwordx2 s[20:21], s[0:1], 112
    s_and_b32 s31, s3, 1
    v_readfirstlane_b32 s30, v2
    s_lshr_b32 s32, s3, 1
    s_waitcnt lgkmcnt(0)
    s_cmp_eq_u32 s31, 0
    s_cselect_b32 s4, s4, s8
    s_cselect_b32 s5, s5, s9
    s_mov_b32 s6, 1966080
    s_mov_b32 s7, 0x00020000
    s_add_u32 s8, s28, 0
    s_addc_u32 s9, s29, 0
    s_mov_b32 s10, 15360
    s_mov_b32 s11, 0x00020000
    v_lshlrev_b32 v3, 2, v0
    s_mov_b32 s33, 10240
    s_mov_b32 s34, 7680
    v_lshrrev_b32 v4, 4, v1
    v_and_b32 v5, 15, v1
    v_mul_u32_u24 v6, 24576, v4
    v_lshl_add_u32 v6, v5, 2, v6
    s_mul_i32 s35, s30, 491520
    s_lshl_b32 s36, s32, 6
    s_add_u32 s35, s35, s36
    buffer_load_dword v10, v6, s[4:7], s35 offen
    s_add_u32 s35, s35, 3072
    buffer_load_dword v11, v6, s[4:7], s35 offen
    s_add_u32 s35, s35, 3072
    buffer_load_dword v12, v6, s[4:7], s35 offen
    s_add_u32 s35, s35, 3072
    buffer_load_dword v13, v6, s[4:7], s35 offen
    s_add_u32 s35, s35, 3072
    buffer_load_dword v14, v6, s[4:7], s35 offen
    s_add_u32 s35, s35, 3072
    buffer_load_dword v15, v6, s[4:7], s35 offen
    s_add_u32 s35, s35, 3072
    buffer_load_dword v16, v6, s[4:7], s35 offen
    s_add_u32 s35, s35, 3072
    buffer_load_dword v17, v6, s[4:7], s35 offen
    s_add_u32 s35, s35, 76800
    buffer_load_dword v18, v6, s[4:7], s35 offen
    s_add_u32 s35, s35, 3072
    buffer_load_dword v19, v6, s[4:7], s35 offen
    s_add_u32 s35, s35, 3072
    buffer_load_dword v20, v6, s[4:7], s35 offen
    s_add_u32 s35, s35, 3072
    buffer_load_dword v21, v6, s[4:7], s35 offen
    s_add_u32 s35, s35, 3072
    buffer_load_dword v22, v6, s[4:7], s35 offen
    s_add_u32 s35, s35, 3072
    buffer_load_dword v23, v6, s[4:7], s35 offen
    s_add_u32 s35, s35, 3072
    buffer_load_dword v24, v6, s[4:7], s35 offen
    s_add_u32 s35, s35, 3072
    buffer_load_dword v25, v6, s[4:7], s35 offen
    s_add_u32 s35, s35, 76800
    buffer_load_dword v26, v6, s[4:7], s35 offen
    s_add_u32 s35, s35, 3072
    buffer_load_dword v27, v6, s[4:7], s35 offen
    s_add_u32 s35, s35, 3072
    buffer_load_dword v28, v6, s[4:7], s35 offen
    s_add_u32 s35, s35, 3072
    buffer_load_dword v29, v6, s[4:7], s35 offen
    s_add_u32 s35, s35, 3072
    buffer_load_dword v30, v6, s[4:7], s35 offen
    s_add_u32 s35, s35, 3072
    buffer_load_dword v31, v6, s[4:7], s35 offen
    s_add_u32 s35, s35, 3072
    buffer_load_dword v32, v6, s[4:7], s35 offen
    s_add_u32 s35, s35, 3072
    buffer_load_dword v33, v6, s[4:7], s35 offen
    s_add_u32 s35, s35, 76800
    buffer_load_dword v34, v6, s[4:7], s35 offen
    s_add_u32 s35, s35, 3072
    buffer_load_dword v35, v6, s[4:7], s35 offen
    s_add_u32 s35, s35, 3072
    buffer_load_dword v36, v6, s[4:7], s35 offen
    s_add_u32 s35, s35, 3072
    buffer_load_dword v37, v6, s[4:7], s35 offen
    s_add_u32 s35, s35, 3072
    buffer_load_dword v38, v6, s[4:7], s35 offen
    s_add_u32 s35, s35, 3072
    buffer_load_dword v39, v6, s[4:7], s35 offen
    s_add_u32 s35, s35, 3072
    buffer_load_dword v40, v6, s[4:7], s35 offen
    s_add_u32 s35, s35, 3072
    buffer_load_dword v41, v6, s[4:7], s35 offen
    s_add_u32 s35, s35, 76800
    buffer_load_dword v42, v6, s[4:7], s35 offen
    s_add_u32 s35, s35, 3072
    buffer_load_dword v43, v6, s[4:7], s35 offen
    s_add_u32 s35, s35, 3072
    buffer_load_dword v44, v6, s[4:7], s35 offen
    s_add_u32 s35, s35, 3072
    buffer_load_dword v45, v6, s[4:7], s35 offen
    s_add_u32 s35, s35, 3072
    buffer_load_dword v46, v6, s[4:7], s35 offen
    s_add_u32 s35, s35, 3072
    buffer_load_dword v47, v6, s[4:7], s35 offen
    s_add_u32 s35, s35, 3072
    buffer_load_dword v48, v6, s[4:7], s35 offen
    s_add_u32 s35, s35, 3072
    buffer_load_dword v49, v6, s[4:7], s35 offen
    s_add_u32 s35, s35, 76800
    s_add_u32 s12, s28, 10485760
    s_addc_u32 s13, s29, 0
    s_mov_b32 s14, 3932160
    s_mov_b32 s15, 0x00020000
    s_add_u32 s16, s28, 32768
    s_addc_u32 s17, s29, 0
    s_mov_b32 s18, 12288
    s_mov_b32 s19, 0x00020000
    s_mov_b32 s22, 256
    s_mov_b32 s23, 0x00020000
    v_mov_b32 v106, 0
    s_cmp_lg_u32 s30, 0
    s_cbranch_scc1 K12_WP_NOPOLL
    buffer_load_dword v107, v106, s[20:23], 0 offen offset:132 sc1
K12_WP_NOPOLL:
    s_cmp_lg_u32 s30, 0
    s_cbranch_scc1 K12_WP_BAR
    s_mov_b32 s70, 4096
    s_branch K12_WP_CHK
K12_WP_LOOP:
    s_sleep 16
    buffer_load_dword v107, v106, s[20:23], 0 offen offset:132 sc1
K12_WP_CHK:
    s_waitcnt vmcnt(0)
    v_readfirstlane_b32 s71, v107
    s_sub_u32 s70, s70, 1
    s_cmp_eq_u32 s70, 0
    s_cbranch_scc1 K12_WP_OK
    s_cmp_lt_u32 s71, 1
    s_cbranch_scc1 K12_WP_LOOP
K12_WP_OK:
K12_WP_BAR:
    s_barrier
    buffer_load_dword v100, v3, s[8:11], s33 offen offset:0 sc1
    buffer_load_dword v103, v3, s[8:11], s34 offen offset:0 sc1
    buffer_load_dword v101, v3, s[8:11], s33 offen offset:1024 sc1
    buffer_load_dword v104, v3, s[8:11], s34 offen offset:1024 sc1
    buffer_load_dword v102, v3, s[8:11], s33 offen offset:2048 sc1
    buffer_load_dword v105, v3, s[8:11], s34 offen offset:2048 sc1
    s_waitcnt vmcnt(0)
    v_add_f32 v100, 1.0, v100
    v_cvt_pk_bf16_f32 v100, v100, v100
    v_lshlrev_b32 v100, 16, v100
    ds_write_b32 v3, v100 offset:0
    ds_write_b32 v3, v103 offset:3072
    v_add_f32 v101, 1.0, v101
    v_cvt_pk_bf16_f32 v101, v101, v101
    v_lshlrev_b32 v101, 16, v101
    ds_write_b32 v3, v101 offset:1024
    ds_write_b32 v3, v104 offset:4096
    v_add_f32 v102, 1.0, v102
    v_cvt_pk_bf16_f32 v102, v102, v102
    v_lshlrev_b32 v102, 16, v102
    ds_write_b32 v3, v102 offset:2048
    ds_write_b32 v3, v105 offset:5120
    s_waitcnt lgkmcnt(0)
    s_barrier
    s_mul_i32 s36, s30, 640
    v_lshl_add_u32 v7, v4, 5, s36
    ds_read_b128 v[64:67], v7 offset:0
    ds_read_b128 v[68:71], v7 offset:16
    ds_read_b128 v[72:75], v7 offset:3072
    ds_read_b128 v[76:79], v7 offset:3088
    ds_read_b128 v[80:83], v7 offset:128
    ds_read_b128 v[84:87], v7 offset:144
    ds_read_b128 v[88:91], v7 offset:3200
    ds_read_b128 v[92:95], v7 offset:3216
    s_waitcnt vmcnt(32) lgkmcnt(4)
    v_lshlrev_b32 v96, 16, v10
    v_and_b32 v97, 0xffff0000, v10
    v_mul_f32 v60, v96, v64
    v_mul_f32 v61, v97, v64
    v_mul_f32 v62, v96, v72
    v_mul_f32 v63, v97, v72
    v_lshlrev_b32 v96, 16, v11
    v_and_b32 v97, 0xffff0000, v11
    v_fma_f32 v60, v96, v65, v60
    v_fma_f32 v61, v97, v65, v61
    v_fma_f32 v62, v96, v73, v62
    v_fma_f32 v63, v97, v73, v63
    v_lshlrev_b32 v96, 16, v12
    v_and_b32 v97, 0xffff0000, v12
    v_fma_f32 v60, v96, v66, v60
    v_fma_f32 v61, v97, v66, v61
    v_fma_f32 v62, v96, v74, v62
    v_fma_f32 v63, v97, v74, v63
    v_lshlrev_b32 v96, 16, v13
    v_and_b32 v97, 0xffff0000, v13
    v_fma_f32 v60, v96, v67, v60
    v_fma_f32 v61, v97, v67, v61
    v_fma_f32 v62, v96, v75, v62
    v_fma_f32 v63, v97, v75, v63
    v_lshlrev_b32 v96, 16, v14
    v_and_b32 v97, 0xffff0000, v14
    v_fma_f32 v60, v96, v68, v60
    v_fma_f32 v61, v97, v68, v61
    v_fma_f32 v62, v96, v76, v62
    v_fma_f32 v63, v97, v76, v63
    v_lshlrev_b32 v96, 16, v15
    v_and_b32 v97, 0xffff0000, v15
    v_fma_f32 v60, v96, v69, v60
    v_fma_f32 v61, v97, v69, v61
    v_fma_f32 v62, v96, v77, v62
    v_fma_f32 v63, v97, v77, v63
    v_lshlrev_b32 v96, 16, v16
    v_and_b32 v97, 0xffff0000, v16
    v_fma_f32 v60, v96, v70, v60
    v_fma_f32 v61, v97, v70, v61
    v_fma_f32 v62, v96, v78, v62
    v_fma_f32 v63, v97, v78, v63
    v_lshlrev_b32 v96, 16, v17
    v_and_b32 v97, 0xffff0000, v17
    v_fma_f32 v60, v96, v71, v60
    v_fma_f32 v61, v97, v71, v61
    v_fma_f32 v62, v96, v79, v62
    v_fma_f32 v63, v97, v79, v63
    ds_read_b128 v[64:67], v7 offset:256
    ds_read_b128 v[68:71], v7 offset:272
    ds_read_b128 v[72:75], v7 offset:3328
    ds_read_b128 v[76:79], v7 offset:3344
    s_waitcnt vmcnt(24) lgkmcnt(4)
    v_lshlrev_b32 v96, 16, v18
    v_and_b32 v97, 0xffff0000, v18
    v_fma_f32 v60, v96, v80, v60
    v_fma_f32 v61, v97, v80, v61
    v_fma_f32 v62, v96, v88, v62
    v_fma_f32 v63, v97, v88, v63
    v_lshlrev_b32 v96, 16, v19
    v_and_b32 v97, 0xffff0000, v19
    v_fma_f32 v60, v96, v81, v60
    v_fma_f32 v61, v97, v81, v61
    v_fma_f32 v62, v96, v89, v62
    v_fma_f32 v63, v97, v89, v63
    v_lshlrev_b32 v96, 16, v20
    v_and_b32 v97, 0xffff0000, v20
    v_fma_f32 v60, v96, v82, v60
    v_fma_f32 v61, v97, v82, v61
    v_fma_f32 v62, v96, v90, v62
    v_fma_f32 v63, v97, v90, v63
    v_lshlrev_b32 v96, 16, v21
    v_and_b32 v97, 0xffff0000, v21
    v_fma_f32 v60, v96, v83, v60
    v_fma_f32 v61, v97, v83, v61
    v_fma_f32 v62, v96, v91, v62
    v_fma_f32 v63, v97, v91, v63
    v_lshlrev_b32 v96, 16, v22
    v_and_b32 v97, 0xffff0000, v22
    v_fma_f32 v60, v96, v84, v60
    v_fma_f32 v61, v97, v84, v61
    v_fma_f32 v62, v96, v92, v62
    v_fma_f32 v63, v97, v92, v63
    v_lshlrev_b32 v96, 16, v23
    v_and_b32 v97, 0xffff0000, v23
    v_fma_f32 v60, v96, v85, v60
    v_fma_f32 v61, v97, v85, v61
    v_fma_f32 v62, v96, v93, v62
    v_fma_f32 v63, v97, v93, v63
    v_lshlrev_b32 v96, 16, v24
    v_and_b32 v97, 0xffff0000, v24
    v_fma_f32 v60, v96, v86, v60
    v_fma_f32 v61, v97, v86, v61
    v_fma_f32 v62, v96, v94, v62
    v_fma_f32 v63, v97, v94, v63
    v_lshlrev_b32 v96, 16, v25
    v_and_b32 v97, 0xffff0000, v25
    v_fma_f32 v60, v96, v87, v60
    v_fma_f32 v61, v97, v87, v61
    v_fma_f32 v62, v96, v95, v62
    v_fma_f32 v63, v97, v95, v63
    ds_read_b128 v[80:83], v7 offset:384
    ds_read_b128 v[84:87], v7 offset:400
    ds_read_b128 v[88:91], v7 offset:3456
    ds_read_b128 v[92:95], v7 offset:3472
    s_waitcnt vmcnt(16) lgkmcnt(4)
    v_lshlrev_b32 v96, 16, v26
    v_and_b32 v97, 0xffff0000, v26
    v_fma_f32 v60, v96, v64, v60
    v_fma_f32 v61, v97, v64, v61
    v_fma_f32 v62, v96, v72, v62
    v_fma_f32 v63, v97, v72, v63
    v_lshlrev_b32 v96, 16, v27
    v_and_b32 v97, 0xffff0000, v27
    v_fma_f32 v60, v96, v65, v60
    v_fma_f32 v61, v97, v65, v61
    v_fma_f32 v62, v96, v73, v62
    v_fma_f32 v63, v97, v73, v63
    v_lshlrev_b32 v96, 16, v28
    v_and_b32 v97, 0xffff0000, v28
    v_fma_f32 v60, v96, v66, v60
    v_fma_f32 v61, v97, v66, v61
    v_fma_f32 v62, v96, v74, v62
    v_fma_f32 v63, v97, v74, v63
    v_lshlrev_b32 v96, 16, v29
    v_and_b32 v97, 0xffff0000, v29
    v_fma_f32 v60, v96, v67, v60
    v_fma_f32 v61, v97, v67, v61
    v_fma_f32 v62, v96, v75, v62
    v_fma_f32 v63, v97, v75, v63
    v_lshlrev_b32 v96, 16, v30
    v_and_b32 v97, 0xffff0000, v30
    v_fma_f32 v60, v96, v68, v60
    v_fma_f32 v61, v97, v68, v61
    v_fma_f32 v62, v96, v76, v62
    v_fma_f32 v63, v97, v76, v63
    v_lshlrev_b32 v96, 16, v31
    v_and_b32 v97, 0xffff0000, v31
    v_fma_f32 v60, v96, v69, v60
    v_fma_f32 v61, v97, v69, v61
    v_fma_f32 v62, v96, v77, v62
    v_fma_f32 v63, v97, v77, v63
    v_lshlrev_b32 v96, 16, v32
    v_and_b32 v97, 0xffff0000, v32
    v_fma_f32 v60, v96, v70, v60
    v_fma_f32 v61, v97, v70, v61
    v_fma_f32 v62, v96, v78, v62
    v_fma_f32 v63, v97, v78, v63
    v_lshlrev_b32 v96, 16, v33
    v_and_b32 v97, 0xffff0000, v33
    v_fma_f32 v60, v96, v71, v60
    v_fma_f32 v61, v97, v71, v61
    v_fma_f32 v62, v96, v79, v62
    v_fma_f32 v63, v97, v79, v63
    ds_read_b128 v[64:67], v7 offset:512
    ds_read_b128 v[68:71], v7 offset:528
    ds_read_b128 v[72:75], v7 offset:3584
    ds_read_b128 v[76:79], v7 offset:3600
    s_waitcnt vmcnt(8) lgkmcnt(4)
    v_lshlrev_b32 v96, 16, v34
    v_and_b32 v97, 0xffff0000, v34
    v_fma_f32 v60, v96, v80, v60
    v_fma_f32 v61, v97, v80, v61
    v_fma_f32 v62, v96, v88, v62
    v_fma_f32 v63, v97, v88, v63
    v_lshlrev_b32 v96, 16, v35
    v_and_b32 v97, 0xffff0000, v35
    v_fma_f32 v60, v96, v81, v60
    v_fma_f32 v61, v97, v81, v61
    v_fma_f32 v62, v96, v89, v62
    v_fma_f32 v63, v97, v89, v63
    v_lshlrev_b32 v96, 16, v36
    v_and_b32 v97, 0xffff0000, v36
    v_fma_f32 v60, v96, v82, v60
    v_fma_f32 v61, v97, v82, v61
    v_fma_f32 v62, v96, v90, v62
    v_fma_f32 v63, v97, v90, v63
    v_lshlrev_b32 v96, 16, v37
    v_and_b32 v97, 0xffff0000, v37
    v_fma_f32 v60, v96, v83, v60
    v_fma_f32 v61, v97, v83, v61
    v_fma_f32 v62, v96, v91, v62
    v_fma_f32 v63, v97, v91, v63
    v_lshlrev_b32 v96, 16, v38
    v_and_b32 v97, 0xffff0000, v38
    v_fma_f32 v60, v96, v84, v60
    v_fma_f32 v61, v97, v84, v61
    v_fma_f32 v62, v96, v92, v62
    v_fma_f32 v63, v97, v92, v63
    v_lshlrev_b32 v96, 16, v39
    v_and_b32 v97, 0xffff0000, v39
    v_fma_f32 v60, v96, v85, v60
    v_fma_f32 v61, v97, v85, v61
    v_fma_f32 v62, v96, v93, v62
    v_fma_f32 v63, v97, v93, v63
    v_lshlrev_b32 v96, 16, v40
    v_and_b32 v97, 0xffff0000, v40
    v_fma_f32 v60, v96, v86, v60
    v_fma_f32 v61, v97, v86, v61
    v_fma_f32 v62, v96, v94, v62
    v_fma_f32 v63, v97, v94, v63
    v_lshlrev_b32 v96, 16, v41
    v_and_b32 v97, 0xffff0000, v41
    v_fma_f32 v60, v96, v87, v60
    v_fma_f32 v61, v97, v87, v61
    v_fma_f32 v62, v96, v95, v62
    v_fma_f32 v63, v97, v95, v63
    s_waitcnt vmcnt(0) lgkmcnt(0)
    v_lshlrev_b32 v96, 16, v42
    v_and_b32 v97, 0xffff0000, v42
    v_fma_f32 v60, v96, v64, v60
    v_fma_f32 v61, v97, v64, v61
    v_fma_f32 v62, v96, v72, v62
    v_fma_f32 v63, v97, v72, v63
    v_lshlrev_b32 v96, 16, v43
    v_and_b32 v97, 0xffff0000, v43
    v_fma_f32 v60, v96, v65, v60
    v_fma_f32 v61, v97, v65, v61
    v_fma_f32 v62, v96, v73, v62
    v_fma_f32 v63, v97, v73, v63
    v_lshlrev_b32 v96, 16, v44
    v_and_b32 v97, 0xffff0000, v44
    v_fma_f32 v60, v96, v66, v60
    v_fma_f32 v61, v97, v66, v61
    v_fma_f32 v62, v96, v74, v62
    v_fma_f32 v63, v97, v74, v63
    v_lshlrev_b32 v96, 16, v45
    v_and_b32 v97, 0xffff0000, v45
    v_fma_f32 v60, v96, v67, v60
    v_fma_f32 v61, v97, v67, v61
    v_fma_f32 v62, v96, v75, v62
    v_fma_f32 v63, v97, v75, v63
    v_lshlrev_b32 v96, 16, v46
    v_and_b32 v97, 0xffff0000, v46
    v_fma_f32 v60, v96, v68, v60
    v_fma_f32 v61, v97, v68, v61
    v_fma_f32 v62, v96, v76, v62
    v_fma_f32 v63, v97, v76, v63
    v_lshlrev_b32 v96, 16, v47
    v_and_b32 v97, 0xffff0000, v47
    v_fma_f32 v60, v96, v69, v60
    v_fma_f32 v61, v97, v69, v61
    v_fma_f32 v62, v96, v77, v62
    v_fma_f32 v63, v97, v77, v63
    v_lshlrev_b32 v96, 16, v48
    v_and_b32 v97, 0xffff0000, v48
    v_fma_f32 v60, v96, v70, v60
    v_fma_f32 v61, v97, v70, v61
    v_fma_f32 v62, v96, v78, v62
    v_fma_f32 v63, v97, v78, v63
    v_lshlrev_b32 v96, 16, v49
    v_and_b32 v97, 0xffff0000, v49
    v_fma_f32 v60, v96, v71, v60
    v_fma_f32 v61, v97, v71, v61
    v_fma_f32 v62, v96, v79, v62
    v_fma_f32 v63, v97, v79, v63
    v_lshlrev_b32 v8, 4, v1
    s_lshl_b32 s36, s30, 10
    v_add_u32 v8, s36, v8
    ds_write_b128 v8, v[60:63] offset:6144
    s_waitcnt lgkmcnt(0)
    s_barrier
    v_lshlrev_b32 v8, 4, v5
    ds_read_b128 v[104:107], v8 offset:6144
    ds_read_b128 v[108:111], v8 offset:6400
    ds_read_b128 v[112:115], v8 offset:6656
    ds_read_b128 v[116:119], v8 offset:6912
    ds_read_b128 v[120:123], v8 offset:7168
    ds_read_b128 v[124:127], v8 offset:7424
    ds_read_b128 v[128:131], v8 offset:7680
    ds_read_b128 v[132:135], v8 offset:7936
    s_waitcnt lgkmcnt(0)
    v_mov_b32 v60, v104
    v_mov_b32 v61, v105
    v_mov_b32 v62, v106
    v_mov_b32 v63, v107
    v_add_f32 v60, v60, v108
    v_add_f32 v61, v61, v109
    v_add_f32 v62, v62, v110
    v_add_f32 v63, v63, v111
    v_add_f32 v60, v60, v112
    v_add_f32 v61, v61, v113
    v_add_f32 v62, v62, v114
    v_add_f32 v63, v63, v115
    v_add_f32 v60, v60, v116
    v_add_f32 v61, v61, v117
    v_add_f32 v62, v62, v118
    v_add_f32 v63, v63, v119
    v_add_f32 v60, v60, v120
    v_add_f32 v61, v61, v121
    v_add_f32 v62, v62, v122
    v_add_f32 v63, v63, v123
    v_add_f32 v60, v60, v124
    v_add_f32 v61, v61, v125
    v_add_f32 v62, v62, v126
    v_add_f32 v63, v63, v127
    v_add_f32 v60, v60, v128
    v_add_f32 v61, v61, v129
    v_add_f32 v62, v62, v130
    v_add_f32 v63, v63, v131
    v_add_f32 v60, v60, v132
    v_add_f32 v61, v61, v133
    v_add_f32 v62, v62, v134
    v_add_f32 v63, v63, v135
    ds_read_b128 v[104:107], v8 offset:8192
    ds_read_b128 v[108:111], v8 offset:8448
    ds_read_b128 v[112:115], v8 offset:8704
    ds_read_b128 v[116:119], v8 offset:8960
    ds_read_b128 v[120:123], v8 offset:9216
    ds_read_b128 v[124:127], v8 offset:9472
    ds_read_b128 v[128:131], v8 offset:9728
    ds_read_b128 v[132:135], v8 offset:9984
    s_waitcnt lgkmcnt(0)
    v_add_f32 v60, v60, v104
    v_add_f32 v61, v61, v105
    v_add_f32 v62, v62, v106
    v_add_f32 v63, v63, v107
    v_add_f32 v60, v60, v108
    v_add_f32 v61, v61, v109
    v_add_f32 v62, v62, v110
    v_add_f32 v63, v63, v111
    v_add_f32 v60, v60, v112
    v_add_f32 v61, v61, v113
    v_add_f32 v62, v62, v114
    v_add_f32 v63, v63, v115
    v_add_f32 v60, v60, v116
    v_add_f32 v61, v61, v117
    v_add_f32 v62, v62, v118
    v_add_f32 v63, v63, v119
    v_add_f32 v60, v60, v120
    v_add_f32 v61, v61, v121
    v_add_f32 v62, v62, v122
    v_add_f32 v63, v63, v123
    v_add_f32 v60, v60, v124
    v_add_f32 v61, v61, v125
    v_add_f32 v62, v62, v126
    v_add_f32 v63, v63, v127
    v_add_f32 v60, v60, v128
    v_add_f32 v61, v61, v129
    v_add_f32 v62, v62, v130
    v_add_f32 v63, v63, v131
    v_add_f32 v60, v60, v132
    v_add_f32 v61, v61, v133
    v_add_f32 v62, v62, v134
    v_add_f32 v63, v63, v135
    ds_read_b128 v[64:67], v7 offset:0
    ds_read_b128 v[68:71], v7 offset:16
    v_mul_f32 v60, 0x3acccccd, v60
    v_mul_f32 v61, 0x3acccccd, v61
    s_mov_b32 s36, 0xbfb8aa3b
    s_mov_b32 s37, 0xbf317218
    s_cmp_eq_u32 s31, 0
    s_cselect_b32 s36, s36, s37
    v_mul_f32 v62, s36, v62
    v_mul_f32 v63, s36, v63
    v_lshrrev_b32 v8, 3, v5
    v_lshlrev_b32 v8, 7, v8
    v_and_b32 v9, 7, v5
    v_lshl_add_u32 v8, v9, 2, v8
    s_lshl_b32 s36, s32, 8
    s_lshl_b32 s37, s31, 6
    s_add_u32 s36, s36, s37
    s_cmp_lg_u32 s30, 0
    s_cbranch_scc1 K12_WP_NOU2
    s_mov_b64 exec, 0xffff
    buffer_store_dword v62, v8, s[16:19], s36 offen
    buffer_store_dword v63, v8, s[16:19], s36 offen offset:32
    s_mov_b64 exec, -1
K12_WP_NOU2:
    v_lshrrev_b32 v8, 1, v4
    v_mul_u32_u24 v8, 6144, v8
    v_lshrrev_b32 v9, 3, v5
    v_lshl_add_u32 v8, v9, 10, v8
    v_and_b32 v9, 1, v4
    v_lshl_add_u32 v8, v9, 9, v8
    v_and_b32 v9, 7, v5
    v_lshl_add_u32 v8, v9, 4, v8
    s_mul_i32 s36, s32, 21846
    s_lshr_b32 s36, s36, 16
    s_mul_i32 s37, s36, 3
    s_sub_u32 s37, s32, s37
    s_mul_i32 s36, s36, 40
    s_mul_i32 s38, s30, 10
    s_add_u32 s36, s36, s38
    s_mul_i32 s36, s36, 6144
    s_lshl_b32 s37, s37, 11
    s_add_u32 s36, s36, s37
    s_lshl_b32 s37, s31, 8
    s_add_u32 s36, s36, s37
    ds_read_b128 v[80:83], v7 offset:128
    ds_read_b128 v[84:87], v7 offset:144
    s_waitcnt lgkmcnt(2)
    v_lshlrev_b32 v96, 16, v10
    v_and_b32 v98, 0xffff0000, v10
    v_fma_f32 v96, v96, v64, -v60
    v_fma_f32 v98, v98, v64, -v61
    v_lshlrev_b32 v97, 16, v11
    v_and_b32 v99, 0xffff0000, v11
    v_fma_f32 v97, v97, v65, -v60
    v_fma_f32 v99, v99, v65, -v61
    v_cvt_pk_bf16_f32 v120, v96, v97
    v_cvt_pk_bf16_f32 v124, v98, v99
    v_lshlrev_b32 v96, 16, v12
    v_and_b32 v98, 0xffff0000, v12
    v_fma_f32 v96, v96, v66, -v60
    v_fma_f32 v98, v98, v66, -v61
    v_lshlrev_b32 v97, 16, v13
    v_and_b32 v99, 0xffff0000, v13
    v_fma_f32 v97, v97, v67, -v60
    v_fma_f32 v99, v99, v67, -v61
    v_cvt_pk_bf16_f32 v121, v96, v97
    v_cvt_pk_bf16_f32 v125, v98, v99
    v_lshlrev_b32 v96, 16, v14
    v_and_b32 v98, 0xffff0000, v14
    v_fma_f32 v96, v96, v68, -v60
    v_fma_f32 v98, v98, v68, -v61
    v_lshlrev_b32 v97, 16, v15
    v_and_b32 v99, 0xffff0000, v15
    v_fma_f32 v97, v97, v69, -v60
    v_fma_f32 v99, v99, v69, -v61
    v_cvt_pk_bf16_f32 v122, v96, v97
    v_cvt_pk_bf16_f32 v126, v98, v99
    v_lshlrev_b32 v96, 16, v16
    v_and_b32 v98, 0xffff0000, v16
    v_fma_f32 v96, v96, v70, -v60
    v_fma_f32 v98, v98, v70, -v61
    v_lshlrev_b32 v97, 16, v17
    v_and_b32 v99, 0xffff0000, v17
    v_fma_f32 v97, v97, v71, -v60
    v_fma_f32 v99, v99, v71, -v61
    v_cvt_pk_bf16_f32 v123, v96, v97
    v_cvt_pk_bf16_f32 v127, v98, v99
    buffer_store_dwordx4 v[120:123], v8, s[12:15], s36 offen sc1
    buffer_store_dwordx4 v[124:127], v8, s[12:15], s36 offen offset:128 sc1
    s_add_u32 s36, s36, 12288
    ds_read_b128 v[64:67], v7 offset:256
    ds_read_b128 v[68:71], v7 offset:272
    s_waitcnt lgkmcnt(2)
    v_lshlrev_b32 v96, 16, v18
    v_and_b32 v98, 0xffff0000, v18
    v_fma_f32 v96, v96, v80, -v60
    v_fma_f32 v98, v98, v80, -v61
    v_lshlrev_b32 v97, 16, v19
    v_and_b32 v99, 0xffff0000, v19
    v_fma_f32 v97, v97, v81, -v60
    v_fma_f32 v99, v99, v81, -v61
    v_cvt_pk_bf16_f32 v128, v96, v97
    v_cvt_pk_bf16_f32 v132, v98, v99
    v_lshlrev_b32 v96, 16, v20
    v_and_b32 v98, 0xffff0000, v20
    v_fma_f32 v96, v96, v82, -v60
    v_fma_f32 v98, v98, v82, -v61
    v_lshlrev_b32 v97, 16, v21
    v_and_b32 v99, 0xffff0000, v21
    v_fma_f32 v97, v97, v83, -v60
    v_fma_f32 v99, v99, v83, -v61
    v_cvt_pk_bf16_f32 v129, v96, v97
    v_cvt_pk_bf16_f32 v133, v98, v99
    v_lshlrev_b32 v96, 16, v22
    v_and_b32 v98, 0xffff0000, v22
    v_fma_f32 v96, v96, v84, -v60
    v_fma_f32 v98, v98, v84, -v61
    v_lshlrev_b32 v97, 16, v23
    v_and_b32 v99, 0xffff0000, v23
    v_fma_f32 v97, v97, v85, -v60
    v_fma_f32 v99, v99, v85, -v61
    v_cvt_pk_bf16_f32 v130, v96, v97
    v_cvt_pk_bf16_f32 v134, v98, v99
    v_lshlrev_b32 v96, 16, v24
    v_and_b32 v98, 0xffff0000, v24
    v_fma_f32 v96, v96, v86, -v60
    v_fma_f32 v98, v98, v86, -v61
    v_lshlrev_b32 v97, 16, v25
    v_and_b32 v99, 0xffff0000, v25
    v_fma_f32 v97, v97, v87, -v60
    v_fma_f32 v99, v99, v87, -v61
    v_cvt_pk_bf16_f32 v131, v96, v97
    v_cvt_pk_bf16_f32 v135, v98, v99
    buffer_store_dwordx4 v[128:131], v8, s[12:15], s36 offen sc1
    buffer_store_dwordx4 v[132:135], v8, s[12:15], s36 offen offset:128 sc1
    s_add_u32 s36, s36, 12288
    ds_read_b128 v[80:83], v7 offset:384
    ds_read_b128 v[84:87], v7 offset:400
    s_waitcnt lgkmcnt(2)
    v_lshlrev_b32 v96, 16, v26
    v_and_b32 v98, 0xffff0000, v26
    v_fma_f32 v96, v96, v64, -v60
    v_fma_f32 v98, v98, v64, -v61
    v_lshlrev_b32 v97, 16, v27
    v_and_b32 v99, 0xffff0000, v27
    v_fma_f32 v97, v97, v65, -v60
    v_fma_f32 v99, v99, v65, -v61
    v_cvt_pk_bf16_f32 v120, v96, v97
    v_cvt_pk_bf16_f32 v124, v98, v99
    v_lshlrev_b32 v96, 16, v28
    v_and_b32 v98, 0xffff0000, v28
    v_fma_f32 v96, v96, v66, -v60
    v_fma_f32 v98, v98, v66, -v61
    v_lshlrev_b32 v97, 16, v29
    v_and_b32 v99, 0xffff0000, v29
    v_fma_f32 v97, v97, v67, -v60
    v_fma_f32 v99, v99, v67, -v61
    v_cvt_pk_bf16_f32 v121, v96, v97
    v_cvt_pk_bf16_f32 v125, v98, v99
    v_lshlrev_b32 v96, 16, v30
    v_and_b32 v98, 0xffff0000, v30
    v_fma_f32 v96, v96, v68, -v60
    v_fma_f32 v98, v98, v68, -v61
    v_lshlrev_b32 v97, 16, v31
    v_and_b32 v99, 0xffff0000, v31
    v_fma_f32 v97, v97, v69, -v60
    v_fma_f32 v99, v99, v69, -v61
    v_cvt_pk_bf16_f32 v122, v96, v97
    v_cvt_pk_bf16_f32 v126, v98, v99
    v_lshlrev_b32 v96, 16, v32
    v_and_b32 v98, 0xffff0000, v32
    v_fma_f32 v96, v96, v70, -v60
    v_fma_f32 v98, v98, v70, -v61
    v_lshlrev_b32 v97, 16, v33
    v_and_b32 v99, 0xffff0000, v33
    v_fma_f32 v97, v97, v71, -v60
    v_fma_f32 v99, v99, v71, -v61
    v_cvt_pk_bf16_f32 v123, v96, v97
    v_cvt_pk_bf16_f32 v127, v98, v99
    buffer_store_dwordx4 v[120:123], v8, s[12:15], s36 offen sc1
    buffer_store_dwordx4 v[124:127], v8, s[12:15], s36 offen offset:128 sc1
    s_add_u32 s36, s36, 12288
    ds_read_b128 v[64:67], v7 offset:512
    ds_read_b128 v[68:71], v7 offset:528
    s_waitcnt lgkmcnt(2)
    v_lshlrev_b32 v96, 16, v34
    v_and_b32 v98, 0xffff0000, v34
    v_fma_f32 v96, v96, v80, -v60
    v_fma_f32 v98, v98, v80, -v61
    v_lshlrev_b32 v97, 16, v35
    v_and_b32 v99, 0xffff0000, v35
    v_fma_f32 v97, v97, v81, -v60
    v_fma_f32 v99, v99, v81, -v61
    v_cvt_pk_bf16_f32 v128, v96, v97
    v_cvt_pk_bf16_f32 v132, v98, v99
    v_lshlrev_b32 v96, 16, v36
    v_and_b32 v98, 0xffff0000, v36
    v_fma_f32 v96, v96, v82, -v60
    v_fma_f32 v98, v98, v82, -v61
    v_lshlrev_b32 v97, 16, v37
    v_and_b32 v99, 0xffff0000, v37
    v_fma_f32 v97, v97, v83, -v60
    v_fma_f32 v99, v99, v83, -v61
    v_cvt_pk_bf16_f32 v129, v96, v97
    v_cvt_pk_bf16_f32 v133, v98, v99
    v_lshlrev_b32 v96, 16, v38
    v_and_b32 v98, 0xffff0000, v38
    v_fma_f32 v96, v96, v84, -v60
    v_fma_f32 v98, v98, v84, -v61
    v_lshlrev_b32 v97, 16, v39
    v_and_b32 v99, 0xffff0000, v39
    v_fma_f32 v97, v97, v85, -v60
    v_fma_f32 v99, v99, v85, -v61
    v_cvt_pk_bf16_f32 v130, v96, v97
    v_cvt_pk_bf16_f32 v134, v98, v99
    v_lshlrev_b32 v96, 16, v40
    v_and_b32 v98, 0xffff0000, v40
    v_fma_f32 v96, v96, v86, -v60
    v_fma_f32 v98, v98, v86, -v61
    v_lshlrev_b32 v97, 16, v41
    v_and_b32 v99, 0xffff0000, v41
    v_fma_f32 v97, v97, v87, -v60
    v_fma_f32 v99, v99, v87, -v61
    v_cvt_pk_bf16_f32 v131, v96, v97
    v_cvt_pk_bf16_f32 v135, v98, v99
    buffer_store_dwordx4 v[128:131], v8, s[12:15], s36 offen sc1
    buffer_store_dwordx4 v[132:135], v8, s[12:15], s36 offen offset:128 sc1
    s_add_u32 s36, s36, 12288
    s_waitcnt lgkmcnt(0)
    v_lshlrev_b32 v96, 16, v42
    v_and_b32 v98, 0xffff0000, v42
    v_fma_f32 v96, v96, v64, -v60
    v_fma_f32 v98, v98, v64, -v61
    v_lshlrev_b32 v97, 16, v43
    v_and_b32 v99, 0xffff0000, v43
    v_fma_f32 v97, v97, v65, -v60
    v_fma_f32 v99, v99, v65, -v61
    v_cvt_pk_bf16_f32 v120, v96, v97
    v_cvt_pk_bf16_f32 v124, v98, v99
    v_lshlrev_b32 v96, 16, v44
    v_and_b32 v98, 0xffff0000, v44
    v_fma_f32 v96, v96, v66, -v60
    v_fma_f32 v98, v98, v66, -v61
    v_lshlrev_b32 v97, 16, v45
    v_and_b32 v99, 0xffff0000, v45
    v_fma_f32 v97, v97, v67, -v60
    v_fma_f32 v99, v99, v67, -v61
    v_cvt_pk_bf16_f32 v121, v96, v97
    v_cvt_pk_bf16_f32 v125, v98, v99
    v_lshlrev_b32 v96, 16, v46
    v_and_b32 v98, 0xffff0000, v46
    v_fma_f32 v96, v96, v68, -v60
    v_fma_f32 v98, v98, v68, -v61
    v_lshlrev_b32 v97, 16, v47
    v_and_b32 v99, 0xffff0000, v47
    v_fma_f32 v97, v97, v69, -v60
    v_fma_f32 v99, v99, v69, -v61
    v_cvt_pk_bf16_f32 v122, v96, v97
    v_cvt_pk_bf16_f32 v126, v98, v99
    v_lshlrev_b32 v96, 16, v48
    v_and_b32 v98, 0xffff0000, v48
    v_fma_f32 v96, v96, v70, -v60
    v_fma_f32 v98, v98, v70, -v61
    v_lshlrev_b32 v97, 16, v49
    v_and_b32 v99, 0xffff0000, v49
    v_fma_f32 v97, v97, v71, -v60
    v_fma_f32 v99, v99, v71, -v61
    v_cvt_pk_bf16_f32 v123, v96, v97
    v_cvt_pk_bf16_f32 v127, v98, v99
    buffer_store_dwordx4 v[120:123], v8, s[12:15], s36 offen sc1
    buffer_store_dwordx4 v[124:127], v8, s[12:15], s36 offen offset:128 sc1
    s_endpgm
K12_END:
.text
.globl k3_gemm1_kernel
.p2align 8
.type k3_gemm1_kernel,@function
k3_gemm1_kernel:
    s_cmp_lt_u32 s2, 256
    s_cbranch_scc1 K3_GO
    s_endpgm
K3_GO:
    s_load_dwordx2 s[28:29], s[0:1], 120
    v_and_b32 v1, 63, v0
    v_lshrrev_b32 v2, 6, v0
    s_and_b32 s31, s2, 7
    v_readfirstlane_b32 s30, v2
    s_lshr_b32 s32, s2, 3
    s_and_b32 s33, s31, 1
    s_lshl_b32 s33, s33, 3
    s_and_b32 s34, s32, 7
    s_add_u32 s33, s33, s34
    s_lshr_b32 s34, s31, 1
    s_lshl_b32 s34, s34, 2
    s_lshr_b32 s35, s32, 3
    s_add_u32 s34, s34, s35
    s_and_b32 s36, s30, 1
    s_lshr_b32 s37, s30, 1
    v_lshlrev_b32 v4, 4, v1
    s_mul_i32 s38, s30, 6144
    v_add_u32 v25, s38, v4
    v_add_u32 v26, 4096, v25
    v_lshrrev_b32 v5, 4, v1
    v_and_b32 v6, 15, v1
    v_lshlrev_b32 v7, 2, v5
    v_xor_b32 v7, v7, v6
    v_lshlrev_b32 v7, 4, v7
    v_lshl_add_u32 v7, v5, 8, v7
    s_lshl_b32 s38, s30, 12
    s_mul_i32 s39, s33, 163840
    s_add_u32 s38, s38, s39
    v_add_u32 v27, s38, v7
    s_mul_i32 s40, s34, 245760
    s_add_u32 s41, s40, 24576
    s_add_u32 s42, s41, 24576
    s_add_u32 s43, s42, 24576
    s_add_u32 s44, s43, 24576
    s_add_u32 s45, s44, 24576
    s_add_u32 s46, s45, 24576
    s_add_u32 s47, s46, 24576
    s_add_u32 s48, s47, 24576
    s_add_u32 s49, s48, 24576
    s_mov_b32 s50, 0
    s_mov_b32 s51, 16384
    s_mov_b32 s52, 32768
    s_mov_b32 s53, 49152
    s_mov_b32 s54, 65536
    s_mov_b32 s55, 81920
    s_mov_b32 s56, 98304
    s_mov_b32 s57, 114688
    s_mov_b32 s58, 131072
    s_mov_b32 s59, 147456
    s_mul_i32 s38, s30, 6144
    s_lshl_b32 s39, s30, 12
    s_add_u32 s60, s38, 0
    s_add_u32 s61, s38, 4096
    s_add_u32 s62, s39, 24576
    s_add_u32 s63, s38, 40960
    s_add_u32 s64, s38, 45056
    s_add_u32 s65, s39, 65536
    s_add_u32 s66, s38, 81920
    s_add_u32 s67, s38, 86016
    s_add_u32 s68, s39, 106496
    s_waitcnt lgkmcnt(0)
    s_add_u32 s4, s28, 10485760
    s_addc_u32 s5, s29, 0
    s_mov_b32 s6, 3932160
    s_mov_b32 s7, 0x00020000
    s_add_u32 s8, s28, 16777216
    s_addc_u32 s9, s29, 0
    s_mov_b32 s10, 2621440
    s_mov_b32 s11, 0x00020000
    s_mov_b32 m0, s62
    s_nop 0
    buffer_load_dwordx4 v27, s[8:11], s50 offen offset:0 lds
    buffer_load_dwordx4 v27, s[8:11], s50 offen offset:1024 lds
    buffer_load_dwordx4 v27, s[8:11], s50 offen offset:2048 lds
    buffer_load_dwordx4 v27, s[8:11], s50 offen offset:3072 lds
    s_mov_b32 m0, s60
    s_nop 0
    buffer_load_dwordx4 v25, s[4:7], s40 offen offset:0 lds
    buffer_load_dwordx4 v25, s[4:7], s40 offen offset:1024 lds
    buffer_load_dwordx4 v25, s[4:7], s40 offen offset:2048 lds
    buffer_load_dwordx4 v25, s[4:7], s40 offen offset:3072 lds
    s_mov_b32 m0, s61
    s_nop 0
    buffer_load_dwordx4 v26, s[4:7], s40 offen offset:0 lds
    buffer_load_dwordx4 v26, s[4:7], s40 offen offset:1024 lds
    s_mov_b32 m0, s65
    s_nop 0
    buffer_load_dwordx4 v27, s[8:11], s51 offen offset:0 lds
    buffer_load_dwordx4 v27, s[8:11], s51 offen offset:1024 lds
    buffer_load_dwordx4 v27, s[8:11], s51 offen offset:2048 lds
    buffer_load_dwordx4 v27, s[8:11], s51 offen offset:3072 lds
    s_mov_b32 m0, s63
    s_nop 0
    buffer_load_dwordx4 v25, s[4:7], s41 offen offset:0 lds
    buffer_load_dwordx4 v25, s[4:7], s41 offen offset:1024 lds
    buffer_load_dwordx4 v25, s[4:7], s41 offen offset:2048 lds
    buffer_load_dwordx4 v25, s[4:7], s41 offen offset:3072 lds
    s_mov_b32 m0, s64
    s_nop 0
    buffer_load_dwordx4 v26, s[4:7], s41 offen offset:0 lds
    buffer_load_dwordx4 v26, s[4:7], s41 offen offset:1024 lds
    s_add_u32 s12, s28, 32768
    s_addc_u32 s13, s29, 0
    s_mov_b32 s14, 12288
    s_mov_b32 s15, 0x00020000
    s_add_u32 s16, s28, 20971520
    s_addc_u32 s17, s29, 0
    s_mov_b32 s18, 6291456
    s_mov_b32 s19, 0x00020000
    v_lshrrev_b32 v8, 5, v1
    v_lshlrev_b32 v9, 4, v8
    s_mul_i32 s38, s34, 6
    s_mul_i32 s39, s37, 3
    s_add_u32 s70, s38, s39
    s_lshl_b32 s71, s70, 7
    s_mul_i32 s38, s37, 3072
    v_add_u32 v10, s38, v4
    v_add_u32 v16, 0, v10
    v_add_u32 v17, 40960, v10
    v_add_u32 v18, 81920, v10
    v_and_b32 v10, 1, v5
    v_lshrrev_b32 v11, 1, v5
    v_lshrrev_b32 v12, 2, v6
    v_and_b32 v13, 3, v6
    v_lshl_add_u32 v11, v11, 3, v12
    v_lshlrev_b32 v11, 8, v11
    v_lshlrev_b32 v10, 1, v10
    v_lshrrev_b32 v14, 1, v13
    v_add_u32 v10, v10, v14
    v_lshl_add_u32 v11, v10, 4, v11
    v_and_b32 v13, 1, v13
    v_lshl_add_u32 v11, v13, 3, v11
    s_lshl_b32 s38, s36, 1
    s_add_u32 s72, s38, s37
    s_xor_b32 s73, s72, 1
    v_xor_b32 v10, s72, v12
    v_lshl_add_u32 v10, v10, 6, v11
    v_add_u32 v19, 24576, v10
    v_add_u32 v20, 65536, v10
    v_add_u32 v21, 106496, v10
    v_xor_b32 v10, s73, v12
    v_lshl_add_u32 v10, v10, 6, v11
    v_add_u32 v22, 24576, v10
    v_add_u32 v23, 65536, v10
    v_add_u32 v24, 106496, v10
    v_mov_b32 v31, 0
    v_mov_b32 v32, 0
    v_mov_b32 v33, 0
    v_mov_b32 v34, 0
    s_mov_b32 s79, 0x3f803f80
    s_add_u32 s40, s40, 49152
    s_mov_b32 s50, 32768
    s_mov_b32 s60, s66
    s_mov_b32 s61, s67
    s_mov_b32 s62, s68
    s_mov_b32 m0, s62
    s_mov_b32 s63, 0
    s_mov_b32 s64, 0
    buffer_load_dwordx4 v27, s[8:11], s50 offen offset:0 lds
    buffer_load_dwordx4 v27, s[8:11], s50 offen offset:1024 lds
    s_mul_i32 s65, s30, 6144
    s_lshl_b32 s69, s30, 12
    s_add_u32 s69, s69, 24576
    s_waitcnt vmcnt(12)
    s_barrier
    v_mov_b32 v17, v16
    v_mov_b32 v20, v19
    v_mov_b32 v23, v22
    ds_read_b64_tr_b16 v[64:65], v19 offset:0
    ds_read_b64_tr_b16 v[66:67], v19 offset:1024
    ds_read_b128 v[40:43], v16 offset:0
    ds_read_b64_tr_b16 v[68:69], v22 offset:0
    ds_read_b64_tr_b16 v[70:71], v22 offset:1024
    ds_read_b128 v[44:47], v16 offset:1024
    ds_read_b128 v[48:51], v16 offset:2048
    s_waitcnt lgkmcnt(0)
    v_mfma_f32_32x32x16_bf16 v[160:175], v[40:43], v[64:67], 0
    ds_read_b64_tr_b16 v[72:73], v19 offset:4096
    ds_read_b64_tr_b16 v[74:75], v19 offset:5120
    ds_read_b128 v[52:55], v16 offset:6144
    ds_read_b64_tr_b16 v[76:77], v22 offset:4096
    ds_read_b64_tr_b16 v[78:79], v22 offset:5120
    ds_read_b128 v[56:59], v16 offset:7168
    ds_read_b128 v[60:63], v16 offset:8192
    buffer_load_dwordx4 v27, s[8:11], s50 offen offset:2048 lds
    v_mfma_f32_32x32x16_bf16 v[176:191], v[40:43], v[68:71], 0
    v_lshlrev_b32 v35, 16, v64
    v_and_b32 v36, 0xffff0000, v64
    v_add_f32 v31, v31, v35
    v_fma_f32 v33, v35, v35, v33
    buffer_load_dwordx4 v27, s[8:11], s50 offen offset:3072 lds
    v_add_f32 v32, v32, v36
    v_fma_f32 v34, v36, v36, v34
    v_lshlrev_b32 v35, 16, v65
    v_mfma_f32_32x32x16_bf16 v[192:207], v[44:47], v[64:67], 0
    v_and_b32 v36, 0xffff0000, v65
    s_mov_b32 m0, s60
    v_add_f32 v31, v31, v35
    v_fma_f32 v33, v35, v35, v33
    v_add_f32 v32, v32, v36
    v_fma_f32 v34, v36, v36, v34
    buffer_load_dwordx4 v25, s[4:7], s40 offen offset:0 lds
    v_lshlrev_b32 v35, 16, v66
    v_mfma_f32_32x32x16_bf16 v[208:223], v[44:47], v[68:71], 0
    v_and_b32 v36, 0xffff0000, v66
    v_add_f32 v31, v31, v35
    v_fma_f32 v33, v35, v35, v33
    v_add_f32 v32, v32, v36
    v_fma_f32 v34, v36, v36, v34
    v_lshlrev_b32 v35, 16, v67
    v_and_b32 v36, 0xffff0000, v67
    v_add_f32 v31, v31, v35
    v_mfma_f32_32x32x16_bf16 v[224:239], v[48:51], v[64:67], 0
    v_fma_f32 v33, v35, v35, v33
    v_add_f32 v32, v32, v36
    v_fma_f32 v34, v36, v36, v34
    buffer_load_dwordx4 v[80:83], v9, s[12:15], s71 offen offset:0
    buffer_load_dwordx4 v[84:87], v9, s[12:15], s71 offen offset:32
    buffer_load_dwordx4 v[88:91], v9, s[12:15], s71 offen offset:64
    buffer_load_dwordx4 v[92:95], v9, s[12:15], s71 offen offset:96
    buffer_load_dwordx4 v[112:115], v9, s[12:15], s71 offen offset:128
    v_mfma_f32_32x32x16_bf16 v[240:255], v[48:51], v[68:71], 0
    buffer_load_dwordx4 v[116:119], v9, s[12:15], s71 offen offset:160
    buffer_load_dwordx4 v[120:123], v9, s[12:15], s71 offen offset:192
    buffer_load_dwordx4 v[124:127], v9, s[12:15], s71 offen offset:224
    buffer_load_dwordx4 v[144:147], v9, s[12:15], s71 offen offset:256
    buffer_load_dwordx4 v[148:151], v9, s[12:15], s71 offen offset:288
    buffer_load_dwordx4 v[152:155], v9, s[12:15], s71 offen offset:320
    buffer_load_dwordx4 v[156:159], v9, s[12:15], s71 offen offset:352
    s_branch K3_L1
K3_LOOP:
    s_waitcnt lgkmcnt(0)
    v_mfma_f32_32x32x16_bf16 v[160:175], v[40:43], v[64:67], v[160:175]
    ds_read_b64_tr_b16 v[72:73], v19 offset:4096
    ds_read_b64_tr_b16 v[74:75], v19 offset:5120
    ds_read_b128 v[52:55], v16 offset:6144
    ds_read_b64_tr_b16 v[76:77], v22 offset:4096
    ds_read_b64_tr_b16 v[78:79], v22 offset:5120
    ds_read_b128 v[56:59], v16 offset:7168
    v_mfma_f32_32x32x16_bf16 v[176:191], v[40:43], v[68:71], v[176:191]
    ds_read_b128 v[60:63], v16 offset:8192
    buffer_load_dwordx4 v27, s[8:11], s50 offen offset:2048 lds
    v_lshlrev_b32 v35, 16, v64
    v_and_b32 v36, 0xffff0000, v64
    v_add_f32 v31, v31, v35
    v_fma_f32 v33, v35, v35, v33
    v_mfma_f32_32x32x16_bf16 v[192:207], v[44:47], v[64:67], v[192:207]
    buffer_load_dwordx4 v27, s[8:11], s50 offen offset:3072 lds
    v_add_f32 v32, v32, v36
    v_fma_f32 v34, v36, v36, v34
    v_lshlrev_b32 v35, 16, v65
    v_and_b32 v36, 0xffff0000, v65
    s_mov_b32 m0, s60
    v_mfma_f32_32x32x16_bf16 v[208:223], v[44:47], v[68:71], v[208:223]
    v_add_f32 v31, v31, v35
    v_fma_f32 v33, v35, v35, v33
    v_add_f32 v32, v32, v36
    v_fma_f32 v34, v36, v36, v34
    buffer_load_dwordx4 v25, s[4:7], s40 offen offset:0 lds
    v_lshlrev_b32 v35, 16, v66
    v_mfma_f32_32x32x16_bf16 v[224:239], v[48:51], v[64:67], v[224:239]
    v_and_b32 v36, 0xffff0000, v66
    v_add_f32 v31, v31, v35
    v_fma_f32 v33, v35, v35, v33
    v_add_f32 v32, v32, v36
    v_fma_f32 v34, v36, v36, v34
    v_lshlrev_b32 v35, 16, v67
    v_mfma_f32_32x32x16_bf16 v[240:255], v[48:51], v[68:71], v[240:255]
    v_and_b32 v36, 0xffff0000, v67
    v_add_f32 v31, v31, v35
    v_fma_f32 v33, v35, v35, v33
    v_add_f32 v32, v32, v36
    v_fma_f32 v34, v36, v36, v34
K3_L1:
    s_waitcnt lgkmcnt(0)
    v_mfma_f32_32x32x16_bf16 v[160:175], v[52:55], v[72:75], v[160:175]
    ds_read_b64_tr_b16 v[64:65], v19 offset:8192
    ds_read_b64_tr_b16 v[66:67], v19 offset:9216
    ds_read_b128 v[40:43], v16 offset:12288
    ds_read_b64_tr_b16 v[68:69], v22 offset:8192
    ds_read_b64_tr_b16 v[70:71], v22 offset:9216
    ds_read_b128 v[44:47], v16 offset:13312
    v_mfma_f32_32x32x16_bf16 v[176:191], v[52:55], v[76:79], v[176:191]
    ds_read_b128 v[48:51], v16 offset:14336
    buffer_load_dwordx4 v25, s[4:7], s40 offen offset:1024 lds
    v_lshlrev_b32 v35, 16, v72
    v_and_b32 v36, 0xffff0000, v72
    v_add_f32 v31, v31, v35
    v_fma_f32 v33, v35, v35, v33
    v_mfma_f32_32x32x16_bf16 v[192:207], v[56:59], v[72:75], v[192:207]
    buffer_load_dwordx4 v25, s[4:7], s40 offen offset:2048 lds
    v_add_f32 v32, v32, v36
    v_fma_f32 v34, v36, v36, v34
    v_lshlrev_b32 v35, 16, v73
    v_and_b32 v36, 0xffff0000, v73
    buffer_load_dwordx4 v25, s[4:7], s40 offen offset:3072 lds
    v_mfma_f32_32x32x16_bf16 v[208:223], v[56:59], v[76:79], v[208:223]
    v_add_f32 v31, v31, v35
    v_fma_f32 v33, v35, v35, v33
    v_add_f32 v32, v32, v36
    v_fma_f32 v34, v36, v36, v34
    v_lshlrev_b32 v35, 16, v74
    v_and_b32 v36, 0xffff0000, v74
    v_mfma_f32_32x32x16_bf16 v[224:239], v[60:63], v[72:75], v[224:239]
    v_add_f32 v31, v31, v35
    v_fma_f32 v33, v35, v35, v33
    v_add_f32 v32, v32, v36
    v_fma_f32 v34, v36, v36, v34
    v_lshlrev_b32 v35, 16, v75
    v_and_b32 v36, 0xffff0000, v75
    v_mfma_f32_32x32x16_bf16 v[240:255], v[60:63], v[76:79], v[240:255]
    v_add_f32 v31, v31, v35
    v_fma_f32 v33, v35, v35, v33
    v_add_f32 v32, v32, v36
    v_fma_f32 v34, v36, v36, v34
    s_waitcnt lgkmcnt(0)
    v_mfma_f32_32x32x16_bf16 v[160:175], v[40:43], v[64:67], v[160:175]
    ds_read_b64_tr_b16 v[72:73], v19 offset:12288
    ds_read_b64_tr_b16 v[74:75], v19 offset:13312
    ds_read_b128 v[52:55], v16 offset:18432
    ds_read_b64_tr_b16 v[76:77], v22 offset:12288
    ds_read_b64_tr_b16 v[78:79], v22 offset:13312
    ds_read_b128 v[56:59], v16 offset:19456
    v_mfma_f32_32x32x16_bf16 v[176:191], v[40:43], v[68:71], v[176:191]
    ds_read_b128 v[60:63], v16 offset:20480
    s_mov_b32 m0, s61
    v_lshlrev_b32 v35, 16, v64
    v_and_b32 v36, 0xffff0000, v64
    v_add_f32 v31, v31, v35
    v_fma_f32 v33, v35, v35, v33
    v_mfma_f32_32x32x16_bf16 v[192:207], v[44:47], v[64:67], v[192:207]
    buffer_load_dwordx4 v26, s[4:7], s40 offen offset:0 lds
    v_add_f32 v32, v32, v36
    v_fma_f32 v34, v36, v36, v34
    v_lshlrev_b32 v35, 16, v65
    v_and_b32 v36, 0xffff0000, v65
    buffer_load_dwordx4 v26, s[4:7], s40 offen offset:1024 lds
    v_mfma_f32_32x32x16_bf16 v[208:223], v[44:47], v[68:71], v[208:223]
    v_add_f32 v31, v31, v35
    v_fma_f32 v33, v35, v35, v33
    v_add_f32 v32, v32, v36
    v_fma_f32 v34, v36, v36, v34
    v_lshlrev_b32 v35, 16, v66
    v_and_b32 v36, 0xffff0000, v66
    v_mfma_f32_32x32x16_bf16 v[224:239], v[48:51], v[64:67], v[224:239]
    v_add_f32 v31, v31, v35
    v_fma_f32 v33, v35, v35, v33
    v_add_f32 v32, v32, v36
    v_fma_f32 v34, v36, v36, v34
    v_lshlrev_b32 v35, 16, v67
    v_and_b32 v36, 0xffff0000, v67
    v_mfma_f32_32x32x16_bf16 v[240:255], v[48:51], v[68:71], v[240:255]
    v_add_f32 v31, v31, v35
    v_fma_f32 v33, v35, v35, v33
    v_add_f32 v32, v32, v36
    v_fma_f32 v34, v36, v36, v34
    s_waitcnt lgkmcnt(0)
    v_mfma_f32_32x32x16_bf16 v[160:175], v[52:55], v[72:75], v[160:175]
    s_waitcnt vmcnt(10)
    s_barrier
    s_add_u32 s40, s40, 24576
    s_add_u32 s50, s50, 16384
    s_add_u32 s60, s65, s63
    s_add_u32 s62, s69, s63
    s_add_u32 s61, s60, 4096
    s_cmp_ge_u32 s64, 7
    s_cselect_b32 s6, 0, s6
    v_mfma_f32_32x32x16_bf16 v[176:191], v[52:55], v[76:79], v[176:191]
    s_cselect_b32 s10, 0, s10
    s_add_u32 s63, s63, 40960
    s_cmp_eq_u32 s63, 122880
    s_cselect_b32 s63, 0, s63
    v_add_u32 v16, s63, v17
    v_add_u32 v19, s63, v20
    v_add_u32 v22, s63, v23
    ds_read_b64_tr_b16 v[64:65], v19 offset:0
    ds_read_b64_tr_b16 v[66:67], v19 offset:1024
    v_mfma_f32_32x32x16_bf16 v[192:207], v[56:59], v[72:75], v[192:207]
    ds_read_b128 v[40:43], v16 offset:0
    ds_read_b64_tr_b16 v[68:69], v22 offset:0
    ds_read_b64_tr_b16 v[70:71], v22 offset:1024
    ds_read_b128 v[44:47], v16 offset:1024
    ds_read_b128 v[48:51], v16 offset:2048
    s_mov_b32 m0, s62
    v_lshlrev_b32 v35, 16, v72
    v_and_b32 v36, 0xffff0000, v72
    v_add_f32 v31, v31, v35
    v_mfma_f32_32x32x16_bf16 v[208:223], v[56:59], v[76:79], v[208:223]
    v_fma_f32 v33, v35, v35, v33
    buffer_load_dwordx4 v27, s[8:11], s50 offen offset:0 lds
    v_add_f32 v32, v32, v36
    v_fma_f32 v34, v36, v36, v34
    v_lshlrev_b32 v35, 16, v73
    v_and_b32 v36, 0xffff0000, v73
    buffer_load_dwordx4 v27, s[8:11], s50 offen offset:1024 lds
    v_add_f32 v31, v31, v35
    v_fma_f32 v33, v35, v35, v33
    v_mfma_f32_32x32x16_bf16 v[224:239], v[60:63], v[72:75], v[224:239]
    v_add_f32 v32, v32, v36
    v_fma_f32 v34, v36, v36, v34
    v_lshlrev_b32 v35, 16, v74
    v_and_b32 v36, 0xffff0000, v74
    v_add_f32 v31, v31, v35
    v_fma_f32 v33, v35, v35, v33
    v_add_f32 v32, v32, v36
    v_fma_f32 v34, v36, v36, v34
    v_lshlrev_b32 v35, 16, v75
    v_mfma_f32_32x32x16_bf16 v[240:255], v[60:63], v[76:79], v[240:255]
    v_and_b32 v36, 0xffff0000, v75
    v_add_f32 v31, v31, v35
    v_fma_f32 v33, v35, v35, v33
    v_add_f32 v32, v32, v36
    v_fma_f32 v34, v36, v36, v34
    s_add_u32 s64, s64, 1
    s_cmp_lt_u32 s64, 10
    s_cbranch_scc1 K3_LOOP
    s_waitcnt vmcnt(0)
    v_add_f32 v31, v31, v32
    v_add_f32 v32, v33, v34
    v_mov_b32 v36, v31
    v_mov_b32 v37, v32
    s_lshl_b32 s38, s72, 9
    s_add_u32 s38, s38, 122880
    v_lshlrev_b32 v10, 3, v1
    v_add_u32 v10, s38, v10
    ds_write_b64 v10, v[36:37]
    v_and_b32 v11, 31, v1
    v_lshlrev_b32 v12, 3, v11
    s_waitcnt lgkmcnt(0)
    s_barrier
    s_lshl_b32 s38, s72, 9
    s_add_u32 s38, s38, 122880
    v_add_u32 v13, s38, v12
    ds_read_b64 v[40:41], v13
    ds_read_b64 v[42:43], v13 offset:256
    s_lshl_b32 s38, s73, 9
    s_add_u32 s38, s38, 122880
    v_add_u32 v13, s38, v12
    ds_read_b64 v[44:45], v13
    ds_read_b64 v[46:47], v13 offset:256
    v_lshrrev_b32 v14, 4, v11
    v_and_b32 v15, 15, v11
    v_lshlrev_b32 v15, 4, v15
    v_lshl_add_u32 v15, v8, 8, v15
    v_lshl_add_u32 v15, v14, 10, v15
    s_lshr_b32 s38, s72, 1
    s_mul_i32 s38, s38, 196608
    s_and_b32 s39, s72, 1
    s_lshl_b32 s39, s39, 11
    s_add_u32 s38, s38, s39
    v_add_u32 v38, s38, v15
    s_lshr_b32 s38, s73, 1
    s_mul_i32 s38, s38, 196608
    s_and_b32 s39, s73, 1
    s_lshl_b32 s39, s39, 11
    s_add_u32 s38, s38, s39
    v_add_u32 v39, s38, v15
    s_mul_i32 s38, s33, 393216
    s_add_u32 s39, s70, 0
    s_lshr_b32 s75, s39, 1
    s_lshl_b32 s75, s75, 12
    s_and_b32 s39, s39, 1
    s_lshl_b32 s39, s39, 9
    s_add_u32 s75, s75, s39
    s_add_u32 s76, s75, s38
    s_add_u32 s39, s70, 1
    s_lshr_b32 s75, s39, 1
    s_lshl_b32 s75, s75, 12
    s_and_b32 s39, s39, 1
    s_lshl_b32 s39, s39, 9
    s_add_u32 s75, s75, s39
    s_add_u32 s77, s75, s38
    s_add_u32 s39, s70, 2
    s_lshr_b32 s75, s39, 1
    s_lshl_b32 s75, s75, 12
    s_and_b32 s39, s39, 1
    s_lshl_b32 s39, s39, 9
    s_add_u32 s75, s75, s39
    s_add_u32 s78, s75, s38
    s_waitcnt lgkmcnt(0)
    v_add_f32 v40, v40, v42
    v_add_f32 v41, v41, v43
    v_mul_f32 v40, 0x3acccccd, v40
    v_mul_f32 v41, 0x3acccccd, v41
    v_fma_f32 v41, -v40, v40, v41
    v_add_f32 v41, 0x3727c5ac, v41
    v_rsq_f32 v41, v41
    s_nop 0
    v_mul_f32 v128, 0xbfb8aa3b, v41
    v_mul_f32 v130, 0xbf317218, v41
    v_add_f32 v44, v44, v46
    v_add_f32 v45, v45, v47
    v_mul_f32 v44, 0x3acccccd, v44
    v_mul_f32 v45, 0x3acccccd, v45
    v_fma_f32 v45, -v44, v44, v45
    v_add_f32 v45, 0x3727c5ac, v45
    v_rsq_f32 v45, v45
    s_nop 0
    v_mul_f32 v129, 0xbfb8aa3b, v45
    v_mul_f32 v131, 0xbf317218, v45
    s_mov_b32 s74, 0
K3_EPI:
    s_set_gpr_idx_on s74, gpr_idx(SRC0,SRC2)
    s_nop 0
    v_fma_f32 v40, v160, v128, v80
    v_fma_f32 v41, v161, v128, v81
    v_fma_f32 v42, v162, v128, v82
    v_fma_f32 v43, v163, v128, v83
    v_fma_f32 v44, v164, v128, v84
    v_fma_f32 v45, v165, v128, v85
    v_fma_f32 v46, v166, v128, v86
    v_fma_f32 v47, v167, v128, v87
    v_fma_f32 v48, v168, v130, v88
    v_fma_f32 v49, v169, v130, v89
    v_fma_f32 v50, v170, v130, v90
    v_fma_f32 v51, v171, v130, v91
    v_fma_f32 v52, v172, v130, v92
    v_fma_f32 v53, v173, v130, v93
    v_fma_f32 v54, v174, v130, v94
    v_fma_f32 v55, v175, v130, v95
    s_set_gpr_idx_off
    s_nop 0
    v_mul_f32 v48, v40, v48
    v_exp_f32 v40, v40
    v_mul_f32 v49, v41, v49
    v_exp_f32 v41, v41
    v_mul_f32 v50, v42, v50
    v_exp_f32 v42, v42
    v_mul_f32 v51, v43, v51
    v_exp_f32 v43, v43
    v_mul_f32 v52, v44, v52
    v_exp_f32 v44, v44
    v_mul_f32 v53, v45, v53
    v_exp_f32 v45, v45
    v_mul_f32 v54, v46, v54
    v_exp_f32 v46, v46
    v_mul_f32 v55, v47, v55
    v_exp_f32 v47, v47
    v_add_f32 v40, 1.0, v40
    v_add_f32 v41, 1.0, v41
    v_add_f32 v42, 1.0, v42
    v_add_f32 v43, 1.0, v43
    v_add_f32 v44, 1.0, v44
    v_add_f32 v45, 1.0, v45
    v_add_f32 v46, 1.0, v46
    v_add_f32 v47, 1.0, v47
    v_rcp_f32 v40, v40
    v_rcp_f32 v41, v41
    v_rcp_f32 v42, v42
    v_rcp_f32 v43, v43
    v_rcp_f32 v44, v44
    v_rcp_f32 v45, v45
    v_rcp_f32 v46, v46
    v_rcp_f32 v47, v47
    v_mul_f32 v48, v48, v40
    v_mul_f32 v49, v49, v41
    v_mul_f32 v50, v50, v42
    v_mul_f32 v51, v51, v43
    v_mul_f32 v52, v52, v44
    v_mul_f32 v53, v53, v45
    v_mul_f32 v54, v54, v46
    v_mul_f32 v55, v55, v47
    v_cvt_pk_bf16_f32 v132, v48, v49
    v_cvt_pk_bf16_f32 v133, v50, v51
    v_cvt_pk_bf16_f32 v134, v52, v53
    v_cvt_pk_bf16_f32 v135, v54, v55
    buffer_store_dwordx4 v[132:135], v38, s[16:19], s76 offen sc1
    s_set_gpr_idx_on s74, gpr_idx(SRC0,SRC2)
    s_nop 0
    v_fma_f32 v40, v176, v129, v80
    v_fma_f32 v41, v177, v129, v81
    v_fma_f32 v42, v178, v129, v82
    v_fma_f32 v43, v179, v129, v83
    v_fma_f32 v44, v180, v129, v84
    v_fma_f32 v45, v181, v129, v85
    v_fma_f32 v46, v182, v129, v86
    v_fma_f32 v47, v183, v129, v87
    v_fma_f32 v48, v184, v131, v88
    v_fma_f32 v49, v185, v131, v89
    v_fma_f32 v50, v186, v131, v90
    v_fma_f32 v51, v187, v131, v91
    v_fma_f32 v52, v188, v131, v92
    v_fma_f32 v53, v189, v131, v93
    v_fma_f32 v54, v190, v131, v94
    v_fma_f32 v55, v191, v131, v95
    s_set_gpr_idx_off
    s_nop 0
    v_mul_f32 v48, v40, v48
    v_exp_f32 v40, v40
    v_mul_f32 v49, v41, v49
    v_exp_f32 v41, v41
    v_mul_f32 v50, v42, v50
    v_exp_f32 v42, v42
    v_mul_f32 v51, v43, v51
    v_exp_f32 v43, v43
    v_mul_f32 v52, v44, v52
    v_exp_f32 v44, v44
    v_mul_f32 v53, v45, v53
    v_exp_f32 v45, v45
    v_mul_f32 v54, v46, v54
    v_exp_f32 v46, v46
    v_mul_f32 v55, v47, v55
    v_exp_f32 v47, v47
    v_add_f32 v40, 1.0, v40
    v_add_f32 v41, 1.0, v41
    v_add_f32 v42, 1.0, v42
    v_add_f32 v43, 1.0, v43
    v_add_f32 v44, 1.0, v44
    v_add_f32 v45, 1.0, v45
    v_add_f32 v46, 1.0, v46
    v_add_f32 v47, 1.0, v47
    v_rcp_f32 v40, v40
    v_rcp_f32 v41, v41
    v_rcp_f32 v42, v42
    v_rcp_f32 v43, v43
    v_rcp_f32 v44, v44
    v_rcp_f32 v45, v45
    v_rcp_f32 v46, v46
    v_rcp_f32 v47, v47
    v_mul_f32 v48, v48, v40
    v_mul_f32 v49, v49, v41
    v_mul_f32 v50, v50, v42
    v_mul_f32 v51, v51, v43
    v_mul_f32 v52, v52, v44
    v_mul_f32 v53, v53, v45
    v_mul_f32 v54, v54, v46
    v_mul_f32 v55, v55, v47
    v_cvt_pk_bf16_f32 v136, v48, v49
    v_cvt_pk_bf16_f32 v137, v50, v51
    v_cvt_pk_bf16_f32 v138, v52, v53
    v_cvt_pk_bf16_f32 v139, v54, v55
    buffer_store_dwordx4 v[136:139], v39, s[16:19], s76 offen sc1
    s_mov_b32 s76, s77
    s_mov_b32 s77, s78
    s_add_u32 s74, s74, 32
    s_cmp_lt_u32 s74, 96
    s_cbranch_scc1 K3_EPI
    s_endpgm
K3_END:
.text
.globl k4_gemm2_kernel
.p2align 8
.type k4_gemm2_kernel,@function
k4_gemm2_kernel:
    s_cmp_lt_u32 s2, 256
    s_cbranch_scc1 K4_GO
    s_endpgm
K4_GO:
    s_load_dwordx2 s[28:29], s[0:1], 120
    s_load_dwordx2 s[20:21], s[0:1], 104
    v_and_b32 v1, 63, v0
    v_lshrrev_b32 v2, 6, v0
    s_and_b32 s31, s2, 7
    v_readfirstlane_b32 s30, v2
    s_lshr_b32 s32, s2, 3
    s_and_b32 s33, s31, 3
    s_lshl_b32 s33, s33, 3
    s_and_b32 s34, s32, 7
    s_add_u32 s33, s33, s34
    s_lshr_b32 s34, s31, 2
    s_lshl_b32 s34, s34, 2
    s_lshr_b32 s35, s32, 3
    s_add_u32 s34, s34, s35
    v_lshlrev_b32 v4, 4, v1
    v_add_u32 v33, 4096, v4
    s_xor_b32 s38, s30, 0
    s_lshl_b32 s38, s38, 10
    v_add_u32 v8, s38, v4
    s_xor_b32 s38, s30, 1
    s_lshl_b32 s38, s38, 10
    v_add_u32 v9, s38, v4
    s_xor_b32 s38, s30, 2
    s_lshl_b32 s38, s38, 10
    v_add_u32 v10, s38, v4
    s_xor_b32 s38, s30, 3
    s_lshl_b32 s38, s38, 10
    v_add_u32 v11, s38, v4
    s_mul_i32 s40, s34, 245760
    s_mul_i32 s38, s30, 61440
    s_add_u32 s40, s40, s38
    s_mul_i32 s52, s33, 196608
    s_mul_i32 s38, s30, 49152
    s_add_u32 s52, s52, s38
    s_add_u32 s41, s40, 5120
    s_add_u32 s53, s52, 4096
    s_add_u32 s42, s41, 5120
    s_add_u32 s54, s53, 4096
    s_add_u32 s43, s42, 5120
    s_add_u32 s55, s54, 4096
    s_add_u32 s44, s43, 5120
    s_add_u32 s56, s55, 4096
    s_add_u32 s45, s44, 5120
    s_add_u32 s57, s56, 4096
    s_add_u32 s46, s45, 5120
    s_add_u32 s58, s57, 4096
    s_add_u32 s47, s46, 5120
    s_add_u32 s59, s58, 4096
    s_add_u32 s48, s47, 5120
    s_add_u32 s60, s59, 4096
    s_add_u32 s49, s48, 5120
    s_add_u32 s61, s60, 4096
    s_add_u32 s50, s49, 5120
    s_add_u32 s62, s61, 4096
    s_add_u32 s51, s50, 5120
    s_add_u32 s63, s62, 4096
    s_waitcnt lgkmcnt(0)
    s_add_u32 s4, s28, 14680064
    s_addc_u32 s5, s29, 0
    s_mov_b32 s6, 1966080
    s_mov_b32 s7, 0x00020000
    s_add_u32 s8, s28, 20971520
    s_addc_u32 s9, s29, 0
    s_mov_b32 s10, 6291456
    s_mov_b32 s11, 0x00020000
    buffer_load_dwordx4 v[60:63], v8, s[8:11], s52 offen
    buffer_load_dwordx4 v[64:67], v9, s[8:11], s52 offen
    buffer_load_dwordx4 v[68:71], v10, s[8:11], s52 offen
    buffer_load_dwordx4 v[72:75], v11, s[8:11], s52 offen
    buffer_load_dwordx4 v[40:43], v4, s[4:7], s40 offen offset:0
    buffer_load_dwordx4 v[44:47], v4, s[4:7], s40 offen offset:1024
    buffer_load_dwordx4 v[48:51], v4, s[4:7], s40 offen offset:2048
    buffer_load_dwordx4 v[52:55], v4, s[4:7], s40 offen offset:3072
    buffer_load_dwordx4 v[56:59], v33, s[4:7], s40 offen
    s_add_u32 s12, s28, 16777216
    s_addc_u32 s13, s29, 0
    s_mov_b32 s14, 2621440
    s_mov_b32 s15, 0x00020000
    s_add_u32 s16, s28, 0
    s_addc_u32 s17, s29, 0
    s_mov_b32 s18, 15360
    s_mov_b32 s19, 0x00020000
    v_lshrrev_b32 v5, 3, v1
    v_and_b32 v6, 7, v1
    v_lshlrev_b32 v6, 4, v6
    v_lshl_add_u32 v6, v5, 8, v6
    s_mul_i32 s38, s34, 20480
    s_mul_i32 s39, s30, 6144
    s_add_u32 s38, s38, s39
    s_lshr_b32 s39, s33, 1
    s_mul_i32 s39, s39, 163840
    s_add_u32 s38, s38, s39
    s_and_b32 s39, s33, 1
    s_lshl_b32 s39, s39, 7
    s_add_u32 s38, s38, s39
    v_add_u32 v6, s38, v6
    s_mul_i32 s39, s30, 3072
    s_mov_b32 m0, s39
    v_add_u32 v7, 1024, v6
    v_add_u32 v12, 2048, v6
    buffer_load_dwordx4 v6, s[12:15], 0 offen lds
    buffer_load_dwordx4 v7, s[12:15], 0 offen offset:1024 lds
    buffer_load_dwordx4 v12, s[12:15], 0 offen offset:2048 lds
    v_lshrrev_b32 v5, 4, v1
    v_lshlrev_b32 v6, 4, v5
    s_mul_i32 s38, s34, 320
    s_add_u32 s38, s38, 12800
    buffer_load_dwordx4 v[12:15], v6, s[16:19], s38 offen offset:0
    buffer_load_dwordx4 v[16:19], v6, s[16:19], s38 offen offset:64
    buffer_load_dwordx4 v[20:23], v6, s[16:19], s38 offen offset:128
    buffer_load_dwordx4 v[24:27], v6, s[16:19], s38 offen offset:192
    buffer_load_dwordx4 v[28:31], v6, s[16:19], s38 offen offset:256
    buffer_load_dwordx4 v[96:99], v8, s[8:11], s53 offen
    buffer_load_dwordx4 v[100:103], v9, s[8:11], s53 offen
    buffer_load_dwordx4 v[104:107], v10, s[8:11], s53 offen
    buffer_load_dwordx4 v[108:111], v11, s[8:11], s53 offen
    buffer_load_dwordx4 v[76:79], v4, s[4:7], s41 offen offset:0
    buffer_load_dwordx4 v[80:83], v4, s[4:7], s41 offen offset:1024
    buffer_load_dwordx4 v[84:87], v4, s[4:7], s41 offen offset:2048
    buffer_load_dwordx4 v[88:91], v4, s[4:7], s41 offen offset:3072
    buffer_load_dwordx4 v[92:95], v33, s[4:7], s41 offen
    buffer_load_dwordx4 v[132:135], v8, s[8:11], s54 offen
    buffer_load_dwordx4 v[136:139], v9, s[8:11], s54 offen
    buffer_load_dwordx4 v[140:143], v10, s[8:11], s54 offen
    buffer_load_dwordx4 v[144:147], v11, s[8:11], s54 offen
    buffer_load_dwordx4 v[112:115], v4, s[4:7], s42 offen offset:0
    buffer_load_dwordx4 v[116:119], v4, s[4:7], s42 offen offset:1024
    buffer_load_dwordx4 v[120:123], v4, s[4:7], s42 offen offset:2048
    buffer_load_dwordx4 v[124:127], v4, s[4:7], s42 offen offset:3072
    buffer_load_dwordx4 v[128:131], v33, s[4:7], s42 offen
    s_mov_b32 s22, 2621440
    s_mov_b32 s23, 0x00020000
    s_waitcnt vmcnt(26)
    v_mfma_f32_16x16x32_bf16 a[0:3], v[40:43], v[60:63], 0
    v_mfma_f32_16x16x32_bf16 a[20:23], v[40:43], v[64:67], 0
    v_mfma_f32_16x16x32_bf16 a[40:43], v[40:43], v[68:71], 0
    v_mfma_f32_16x16x32_bf16 a[60:63], v[40:43], v[72:75], 0
    v_mfma_f32_16x16x32_bf16 a[4:7], v[44:47], v[60:63], 0
    v_mfma_f32_16x16x32_bf16 a[24:27], v[44:47], v[64:67], 0
    v_mfma_f32_16x16x32_bf16 a[44:47], v[44:47], v[68:71], 0
    v_mfma_f32_16x16x32_bf16 a[64:67], v[44:47], v[72:75], 0
    buffer_load_dwordx4 v[40:43], v4, s[4:7], s43 offen offset:0
    v_mfma_f32_16x16x32_bf16 a[8:11], v[48:51], v[60:63], 0
    v_mfma_f32_16x16x32_bf16 a[28:31], v[48:51], v[64:67], 0
    v_mfma_f32_16x16x32_bf16 a[48:51], v[48:51], v[68:71], 0
    v_mfma_f32_16x16x32_bf16 a[68:71], v[48:51], v[72:75], 0
    buffer_load_dwordx4 v[44:47], v4, s[4:7], s43 offen offset:1024
    v_mfma_f32_16x16x32_bf16 a[12:15], v[52:55], v[60:63], 0
    v_mfma_f32_16x16x32_bf16 a[32:35], v[52:55], v[64:67], 0
    v_mfma_f32_16x16x32_bf16 a[52:55], v[52:55], v[68:71], 0
    v_mfma_f32_16x16x32_bf16 a[72:75], v[52:55], v[72:75], 0
    buffer_load_dwordx4 v[48:51], v4, s[4:7], s43 offen offset:2048
    v_mfma_f32_16x16x32_bf16 a[16:19], v[56:59], v[60:63], 0
    v_mfma_f32_16x16x32_bf16 a[36:39], v[56:59], v[64:67], 0
    v_mfma_f32_16x16x32_bf16 a[56:59], v[56:59], v[68:71], 0
    v_mfma_f32_16x16x32_bf16 a[76:79], v[56:59], v[72:75], 0
    buffer_load_dwordx4 v[52:55], v4, s[4:7], s43 offen offset:3072
    buffer_load_dwordx4 v[56:59], v33, s[4:7], s43 offen
    buffer_load_dwordx4 v[60:63], v8, s[8:11], s55 offen
    buffer_load_dwordx4 v[64:67], v9, s[8:11], s55 offen
    buffer_load_dwordx4 v[68:71], v10, s[8:11], s55 offen
    buffer_load_dwordx4 v[72:75], v11, s[8:11], s55 offen
    s_waitcnt vmcnt(18)
    v_mfma_f32_16x16x32_bf16 a[0:3], v[76:79], v[96:99], a[0:3]
    v_mfma_f32_16x16x32_bf16 a[20:23], v[76:79], v[100:103], a[20:23]
    v_mfma_f32_16x16x32_bf16 a[40:43], v[76:79], v[104:107], a[40:43]
    v_mfma_f32_16x16x32_bf16 a[60:63], v[76:79], v[108:111], a[60:63]
    v_mfma_f32_16x16x32_bf16 a[4:7], v[80:83], v[96:99], a[4:7]
    v_mfma_f32_16x16x32_bf16 a[24:27], v[80:83], v[100:103], a[24:27]
    v_mfma_f32_16x16x32_bf16 a[44:47], v[80:83], v[104:107], a[44:47]
    v_mfma_f32_16x16x32_bf16 a[64:67], v[80:83], v[108:111], a[64:67]
    buffer_load_dwordx4 v[76:79], v4, s[4:7], s44 offen offset:0
    v_mfma_f32_16x16x32_bf16 a[8:11], v[84:87], v[96:99], a[8:11]
    v_mfma_f32_16x16x32_bf16 a[28:31], v[84:87], v[100:103], a[28:31]
    v_mfma_f32_16x16x32_bf16 a[48:51], v[84:87], v[104:107], a[48:51]
    v_mfma_f32_16x16x32_bf16 a[68:71], v[84:87], v[108:111], a[68:71]
    buffer_load_dwordx4 v[80:83], v4, s[4:7], s44 offen offset:1024
    v_mfma_f32_16x16x32_bf16 a[12:15], v[88:91], v[96:99], a[12:15]
    v_mfma_f32_16x16x32_bf16 a[32:35], v[88:91], v[100:103], a[32:35]
    v_mfma_f32_16x16x32_bf16 a[52:55], v[88:91], v[104:107], a[52:55]
    v_mfma_f32_16x16x32_bf16 a[72:75], v[88:91], v[108:111], a[72:75]
    buffer_load_dwordx4 v[84:87], v4, s[4:7], s44 offen offset:2048
    v_mfma_f32_16x16x32_bf16 a[16:19], v[92:95], v[96:99], a[16:19]
    v_mfma_f32_16x16x32_bf16 a[36:39], v[92:95], v[100:103], a[36:39]
    v_mfma_f32_16x16x32_bf16 a[56:59], v[92:95], v[104:107], a[56:59]
    v_mfma_f32_16x16x32_bf16 a[76:79], v[92:95], v[108:111], a[76:79]
    buffer_load_dwordx4 v[88:91], v4, s[4:7], s44 offen offset:3072
    buffer_load_dwordx4 v[92:95], v33, s[4:7], s44 offen
    buffer_load_dwordx4 v[96:99], v8, s[8:11], s56 offen
    buffer_load_dwordx4 v[100:103], v9, s[8:11], s56 offen
    buffer_load_dwordx4 v[104:107], v10, s[8:11], s56 offen
    buffer_load_dwordx4 v[108:111], v11, s[8:11], s56 offen
    s_waitcnt vmcnt(18)
    v_mfma_f32_16x16x32_bf16 a[0:3], v[112:115], v[132:135], a[0:3]
    v_mfma_f32_16x16x32_bf16 a[20:23], v[112:115], v[136:139], a[20:23]
    v_mfma_f32_16x16x32_bf16 a[40:43], v[112:115], v[140:143], a[40:43]
    v_mfma_f32_16x16x32_bf16 a[60:63], v[112:115], v[144:147], a[60:63]
    v_mfma_f32_16x16x32_bf16 a[4:7], v[116:119], v[132:135], a[4:7]
    v_mfma_f32_16x16x32_bf16 a[24:27], v[116:119], v[136:139], a[24:27]
    v_mfma_f32_16x16x32_bf16 a[44:47], v[116:119], v[140:143], a[44:47]
    v_mfma_f32_16x16x32_bf16 a[64:67], v[116:119], v[144:147], a[64:67]
    buffer_load_dwordx4 v[112:115], v4, s[4:7], s45 offen offset:0
    v_mfma_f32_16x16x32_bf16 a[8:11], v[120:123], v[132:135], a[8:11]
    v_mfma_f32_16x16x32_bf16 a[28:31], v[120:123], v[136:139], a[28:31]
    v_mfma_f32_16x16x32_bf16 a[48:51], v[120:123], v[140:143], a[48:51]
    v_mfma_f32_16x16x32_bf16 a[68:71], v[120:123], v[144:147], a[68:71]
    buffer_load_dwordx4 v[116:119], v4, s[4:7], s45 offen offset:1024
    v_mfma_f32_16x16x32_bf16 a[12:15], v[124:127], v[132:135], a[12:15]
    v_mfma_f32_16x16x32_bf16 a[32:35], v[124:127], v[136:139], a[32:35]
    v_mfma_f32_16x16x32_bf16 a[52:55], v[124:127], v[140:143], a[52:55]
    v_mfma_f32_16x16x32_bf16 a[72:75], v[124:127], v[144:147], a[72:75]
    buffer_load_dwordx4 v[120:123], v4, s[4:7], s45 offen offset:2048
    v_mfma_f32_16x16x32_bf16 a[16:19], v[128:131], v[132:135], a[16:19]
    v_mfma_f32_16x16x32_bf16 a[36:39], v[128:131], v[136:139], a[36:39]
    v_mfma_f32_16x16x32_bf16 a[56:59], v[128:131], v[140:143], a[56:59]
    v_mfma_f32_16x16x32_bf16 a[76:79], v[128:131], v[144:147], a[76:79]
    buffer_load_dwordx4 v[124:127], v4, s[4:7], s45 offen offset:3072
    buffer_load_dwordx4 v[128:131], v33, s[4:7], s45 offen
    buffer_load_dwordx4 v[132:135], v8, s[8:11], s57 offen
    buffer_load_dwordx4 v[136:139], v9, s[8:11], s57 offen
    buffer_load_dwordx4 v[140:143], v10, s[8:11], s57 offen
    buffer_load_dwordx4 v[144:147], v11, s[8:11], s57 offen
    s_waitcnt vmcnt(18)
    v_mfma_f32_16x16x32_bf16 a[0:3], v[40:43], v[60:63], a[0:3]
    v_mfma_f32_16x16x32_bf16 a[20:23], v[40:43], v[64:67], a[20:23]
    v_mfma_f32_16x16x32_bf16 a[40:43], v[40:43], v[68:71], a[40:43]
    v_mfma_f32_16x16x32_bf16 a[60:63], v[40:43], v[72:75], a[60:63]
    v_mfma_f32_16x16x32_bf16 a[4:7], v[44:47], v[60:63], a[4:7]
    v_mfma_f32_16x16x32_bf16 a[24:27], v[44:47], v[64:67], a[24:27]
    v_mfma_f32_16x16x32_bf16 a[44:47], v[44:47], v[68:71], a[44:47]
    v_mfma_f32_16x16x32_bf16 a[64:67], v[44:47], v[72:75], a[64:67]
    buffer_load_dwordx4 v[40:43], v4, s[4:7], s46 offen offset:0
    v_mfma_f32_16x16x32_bf16 a[8:11], v[48:51], v[60:63], a[8:11]
    v_mfma_f32_16x16x32_bf16 a[28:31], v[48:51], v[64:67], a[28:31]
    v_mfma_f32_16x16x32_bf16 a[48:51], v[48:51], v[68:71], a[48:51]
    v_mfma_f32_16x16x32_bf16 a[68:71], v[48:51], v[72:75], a[68:71]
    buffer_load_dwordx4 v[44:47], v4, s[4:7], s46 offen offset:1024
    v_mfma_f32_16x16x32_bf16 a[12:15], v[52:55], v[60:63], a[12:15]
    v_mfma_f32_16x16x32_bf16 a[32:35], v[52:55], v[64:67], a[32:35]
    v_mfma_f32_16x16x32_bf16 a[52:55], v[52:55], v[68:71], a[52:55]
    v_mfma_f32_16x16x32_bf16 a[72:75], v[52:55], v[72:75], a[72:75]
    buffer_load_dwordx4 v[48:51], v4, s[4:7], s46 offen offset:2048
    v_mfma_f32_16x16x32_bf16 a[16:19], v[56:59], v[60:63], a[16:19]
    v_mfma_f32_16x16x32_bf16 a[36:39], v[56:59], v[64:67], a[36:39]
    v_mfma_f32_16x16x32_bf16 a[56:59], v[56:59], v[68:71], a[56:59]
    v_mfma_f32_16x16x32_bf16 a[76:79], v[56:59], v[72:75], a[76:79]
    buffer_load_dwordx4 v[52:55], v4, s[4:7], s46 offen offset:3072
    buffer_load_dwordx4 v[56:59], v33, s[4:7], s46 offen
    buffer_load_dwordx4 v[60:63], v8, s[8:11], s58 offen
    buffer_load_dwordx4 v[64:67], v9, s[8:11], s58 offen
    buffer_load_dwordx4 v[68:71], v10, s[8:11], s58 offen
    buffer_load_dwordx4 v[72:75], v11, s[8:11], s58 offen
    s_waitcnt vmcnt(18)
    v_mfma_f32_16x16x32_bf16 a[0:3], v[76:79], v[96:99], a[0:3]
    v_mfma_f32_16x16x32_bf16 a[20:23], v[76:79], v[100:103], a[20:23]
    v_mfma_f32_16x16x32_bf16 a[40:43], v[76:79], v[104:107], a[40:43]
    v_mfma_f32_16x16x32_bf16 a[60:63], v[76:79], v[108:111], a[60:63]
    v_mfma_f32_16x16x32_bf16 a[4:7], v[80:83], v[96:99], a[4:7]
    v_mfma_f32_16x16x32_bf16 a[24:27], v[80:83], v[100:103], a[24:27]
    v_mfma_f32_16x16x32_bf16 a[44:47], v[80:83], v[104:107], a[44:47]
    v_mfma_f32_16x16x32_bf16 a[64:67], v[80:83], v[108:111], a[64:67]
    buffer_load_dwordx4 v[76:79], v4, s[4:7], s47 offen offset:0
    v_mfma_f32_16x16x32_bf16 a[8:11], v[84:87], v[96:99], a[8:11]
    v_mfma_f32_16x16x32_bf16 a[28:31], v[84:87], v[100:103], a[28:31]
    v_mfma_f32_16x16x32_bf16 a[48:51], v[84:87], v[104:107], a[48:51]
    v_mfma_f32_16x16x32_bf16 a[68:71], v[84:87], v[108:111], a[68:71]
    buffer_load_dwordx4 v[80:83], v4, s[4:7], s47 offen offset:1024
    v_mfma_f32_16x16x32_bf16 a[12:15], v[88:91], v[96:99], a[12:15]
    v_mfma_f32_16x16x32_bf16 a[32:35], v[88:91], v[100:103], a[32:35]
    v_mfma_f32_16x16x32_bf16 a[52:55], v[88:91], v[104:107], a[52:55]
    v_mfma_f32_16x16x32_bf16 a[72:75], v[88:91], v[108:111], a[72:75]
    buffer_load_dwordx4 v[84:87], v4, s[4:7], s47 offen offset:2048
    v_mfma_f32_16x16x32_bf16 a[16:19], v[92:95], v[96:99], a[16:19]
    v_mfma_f32_16x16x32_bf16 a[36:39], v[92:95], v[100:103], a[36:39]
    v_mfma_f32_16x16x32_bf16 a[56:59], v[92:95], v[104:107], a[56:59]
    v_mfma_f32_16x16x32_bf16 a[76:79], v[92:95], v[108:111], a[76:79]
    buffer_load_dwordx4 v[88:91], v4, s[4:7], s47 offen offset:3072
    buffer_load_dwordx4 v[92:95], v33, s[4:7], s47 offen
    buffer_load_dwordx4 v[96:99], v8, s[8:11], s59 offen
    buffer_load_dwordx4 v[100:103], v9, s[8:11], s59 offen
    buffer_load_dwordx4 v[104:107], v10, s[8:11], s59 offen
    buffer_load_dwordx4 v[108:111], v11, s[8:11], s59 offen
    s_waitcnt vmcnt(18)
    v_mfma_f32_16x16x32_bf16 a[0:3], v[112:115], v[132:135], a[0:3]
    v_mfma_f32_16x16x32_bf16 a[20:23], v[112:115], v[136:139], a[20:23]
    v_mfma_f32_16x16x32_bf16 a[40:43], v[112:115], v[140:143], a[40:43]
    v_mfma_f32_16x16x32_bf16 a[60:63], v[112:115], v[144:147], a[60:63]
    v_mfma_f32_16x16x32_bf16 a[4:7], v[116:119], v[132:135], a[4:7]
    v_mfma_f32_16x16x32_bf16 a[24:27], v[116:119], v[136:139], a[24:27]
    v_mfma_f32_16x16x32_bf16 a[44:47], v[116:119], v[140:143], a[44:47]
    v_mfma_f32_16x16x32_bf16 a[64:67], v[116:119], v[144:147], a[64:67]
    buffer_load_dwordx4 v[112:115], v4, s[4:7], s48 offen offset:0
    v_mfma_f32_16x16x32_bf16 a[8:11], v[120:123], v[132:135], a[8:11]
    v_mfma_f32_16x16x32_bf16 a[28:31], v[120:123], v[136:139], a[28:31]
    v_mfma_f32_16x16x32_bf16 a[48:51], v[120:123], v[140:143], a[48:51]
    v_mfma_f32_16x16x32_bf16 a[68:71], v[120:123], v[144:147], a[68:71]
    buffer_load_dwordx4 v[116:119], v4, s[4:7], s48 offen offset:1024
    v_mfma_f32_16x16x32_bf16 a[12:15], v[124:127], v[132:135], a[12:15]
    v_mfma_f32_16x16x32_bf16 a[32:35], v[124:127], v[136:139], a[32:35]
    v_mfma_f32_16x16x32_bf16 a[52:55], v[124:127], v[140:143], a[52:55]
    v_mfma_f32_16x16x32_bf16 a[72:75], v[124:127], v[144:147], a[72:75]
    buffer_load_dwordx4 v[120:123], v4, s[4:7], s48 offen offset:2048
    v_mfma_f32_16x16x32_bf16 a[16:19], v[128:131], v[132:135], a[16:19]
    v_mfma_f32_16x16x32_bf16 a[36:39], v[128:131], v[136:139], a[36:39]
    v_mfma_f32_16x16x32_bf16 a[56:59], v[128:131], v[140:143], a[56:59]
    v_mfma_f32_16x16x32_bf16 a[76:79], v[128:131], v[144:147], a[76:79]
    buffer_load_dwordx4 v[124:127], v4, s[4:7], s48 offen offset:3072
    buffer_load_dwordx4 v[128:131], v33, s[4:7], s48 offen
    buffer_load_dwordx4 v[132:135], v8, s[8:11], s60 offen
    buffer_load_dwordx4 v[136:139], v9, s[8:11], s60 offen
    buffer_load_dwordx4 v[140:143], v10, s[8:11], s60 offen
    buffer_load_dwordx4 v[144:147], v11, s[8:11], s60 offen
    s_waitcnt vmcnt(18)
    v_mfma_f32_16x16x32_bf16 a[0:3], v[40:43], v[60:63], a[0:3]
    v_mfma_f32_16x16x32_bf16 a[20:23], v[40:43], v[64:67], a[20:23]
    v_mfma_f32_16x16x32_bf16 a[40:43], v[40:43], v[68:71], a[40:43]
    v_mfma_f32_16x16x32_bf16 a[60:63], v[40:43], v[72:75], a[60:63]
    v_mfma_f32_16x16x32_bf16 a[4:7], v[44:47], v[60:63], a[4:7]
    v_mfma_f32_16x16x32_bf16 a[24:27], v[44:47], v[64:67], a[24:27]
    v_mfma_f32_16x16x32_bf16 a[44:47], v[44:47], v[68:71], a[44:47]
    v_mfma_f32_16x16x32_bf16 a[64:67], v[44:47], v[72:75], a[64:67]
    buffer_load_dwordx4 v[40:43], v4, s[4:7], s49 offen offset:0
    v_mfma_f32_16x16x32_bf16 a[8:11], v[48:51], v[60:63], a[8:11]
    v_mfma_f32_16x16x32_bf16 a[28:31], v[48:51], v[64:67], a[28:31]
    v_mfma_f32_16x16x32_bf16 a[48:51], v[48:51], v[68:71], a[48:51]
    v_mfma_f32_16x16x32_bf16 a[68:71], v[48:51], v[72:75], a[68:71]
    buffer_load_dwordx4 v[44:47], v4, s[4:7], s49 offen offset:1024
    v_mfma_f32_16x16x32_bf16 a[12:15], v[52:55], v[60:63], a[12:15]
    v_mfma_f32_16x16x32_bf16 a[32:35], v[52:55], v[64:67], a[32:35]
    v_mfma_f32_16x16x32_bf16 a[52:55], v[52:55], v[68:71], a[52:55]
    v_mfma_f32_16x16x32_bf16 a[72:75], v[52:55], v[72:75], a[72:75]
    buffer_load_dwordx4 v[48:51], v4, s[4:7], s49 offen offset:2048
    v_mfma_f32_16x16x32_bf16 a[16:19], v[56:59], v[60:63], a[16:19]
    v_mfma_f32_16x16x32_bf16 a[36:39], v[56:59], v[64:67], a[36:39]
    v_mfma_f32_16x16x32_bf16 a[56:59], v[56:59], v[68:71], a[56:59]
    v_mfma_f32_16x16x32_bf16 a[76:79], v[56:59], v[72:75], a[76:79]
    buffer_load_dwordx4 v[52:55], v4, s[4:7], s49 offen offset:3072
    buffer_load_dwordx4 v[56:59], v33, s[4:7], s49 offen
    buffer_load_dwordx4 v[60:63], v8, s[8:11], s61 offen
    buffer_load_dwordx4 v[64:67], v9, s[8:11], s61 offen
    buffer_load_dwordx4 v[68:71], v10, s[8:11], s61 offen
    buffer_load_dwordx4 v[72:75], v11, s[8:11], s61 offen
    s_waitcnt vmcnt(18)
    v_mfma_f32_16x16x32_bf16 a[0:3], v[76:79], v[96:99], a[0:3]
    v_mfma_f32_16x16x32_bf16 a[20:23], v[76:79], v[100:103], a[20:23]
    v_mfma_f32_16x16x32_bf16 a[40:43], v[76:79], v[104:107], a[40:43]
    v_mfma_f32_16x16x32_bf16 a[60:63], v[76:79], v[108:111], a[60:63]
    v_mfma_f32_16x16x32_bf16 a[4:7], v[80:83], v[96:99], a[4:7]
    v_mfma_f32_16x16x32_bf16 a[24:27], v[80:83], v[100:103], a[24:27]
    v_mfma_f32_16x16x32_bf16 a[44:47], v[80:83], v[104:107], a[44:47]
    v_mfma_f32_16x16x32_bf16 a[64:67], v[80:83], v[108:111], a[64:67]
    buffer_load_dwordx4 v[76:79], v4, s[4:7], s50 offen offset:0
    v_mfma_f32_16x16x32_bf16 a[8:11], v[84:87], v[96:99], a[8:11]
    v_mfma_f32_16x16x32_bf16 a[28:31], v[84:87], v[100:103], a[28:31]
    v_mfma_f32_16x16x32_bf16 a[48:51], v[84:87], v[104:107], a[48:51]
    v_mfma_f32_16x16x32_bf16 a[68:71], v[84:87], v[108:111], a[68:71]
    buffer_load_dwordx4 v[80:83], v4, s[4:7], s50 offen offset:1024
    v_mfma_f32_16x16x32_bf16 a[12:15], v[88:91], v[96:99], a[12:15]
    v_mfma_f32_16x16x32_bf16 a[32:35], v[88:91], v[100:103], a[32:35]
    v_mfma_f32_16x16x32_bf16 a[52:55], v[88:91], v[104:107], a[52:55]
    v_mfma_f32_16x16x32_bf16 a[72:75], v[88:91], v[108:111], a[72:75]
    buffer_load_dwordx4 v[84:87], v4, s[4:7], s50 offen offset:2048
    v_mfma_f32_16x16x32_bf16 a[16:19], v[92:95], v[96:99], a[16:19]
    v_mfma_f32_16x16x32_bf16 a[36:39], v[92:95], v[100:103], a[36:39]
    v_mfma_f32_16x16x32_bf16 a[56:59], v[92:95], v[104:107], a[56:59]
    v_mfma_f32_16x16x32_bf16 a[76:79], v[92:95], v[108:111], a[76:79]
    buffer_load_dwordx4 v[88:91], v4, s[4:7], s50 offen offset:3072
    buffer_load_dwordx4 v[92:95], v33, s[4:7], s50 offen
    buffer_load_dwordx4 v[96:99], v8, s[8:11], s62 offen
    buffer_load_dwordx4 v[100:103], v9, s[8:11], s62 offen
    buffer_load_dwordx4 v[104:107], v10, s[8:11], s62 offen
    buffer_load_dwordx4 v[108:111], v11, s[8:11], s62 offen
    s_waitcnt vmcnt(18)
    v_mfma_f32_16x16x32_bf16 a[0:3], v[112:115], v[132:135], a[0:3]
    v_mfma_f32_16x16x32_bf16 a[20:23], v[112:115], v[136:139], a[20:23]
    v_mfma_f32_16x16x32_bf16 a[40:43], v[112:115], v[140:143], a[40:43]
    v_mfma_f32_16x16x32_bf16 a[60:63], v[112:115], v[144:147], a[60:63]
    v_mfma_f32_16x16x32_bf16 a[4:7], v[116:119], v[132:135], a[4:7]
    v_mfma_f32_16x16x32_bf16 a[24:27], v[116:119], v[136:139], a[24:27]
    v_mfma_f32_16x16x32_bf16 a[44:47], v[116:119], v[140:143], a[44:47]
    v_mfma_f32_16x16x32_bf16 a[64:67], v[116:119], v[144:147], a[64:67]
    buffer_load_dwordx4 v[112:115], v4, s[4:7], s51 offen offset:0
    v_mfma_f32_16x16x32_bf16 a[8:11], v[120:123], v[132:135], a[8:11]
    v_mfma_f32_16x16x32_bf16 a[28:31], v[120:123], v[136:139], a[28:31]
    v_mfma_f32_16x16x32_bf16 a[48:51], v[120:123], v[140:143], a[48:51]
    v_mfma_f32_16x16x32_bf16 a[68:71], v[120:123], v[144:147], a[68:71]
    buffer_load_dwordx4 v[116:119], v4, s[4:7], s51 offen offset:1024
    v_mfma_f32_16x16x32_bf16 a[12:15], v[124:127], v[132:135], a[12:15]
    v_mfma_f32_16x16x32_bf16 a[32:35], v[124:127], v[136:139], a[32:35]
    v_mfma_f32_16x16x32_bf16 a[52:55], v[124:127], v[140:143], a[52:55]
    v_mfma_f32_16x16x32_bf16 a[72:75], v[124:127], v[144:147], a[72:75]
    buffer_load_dwordx4 v[120:123], v4, s[4:7], s51 offen offset:2048
    v_mfma_f32_16x16x32_bf16 a[16:19], v[128:131], v[132:135], a[16:19]
    v_mfma_f32_16x16x32_bf16 a[36:39], v[128:131], v[136:139], a[36:39]
    v_mfma_f32_16x16x32_bf16 a[56:59], v[128:131], v[140:143], a[56:59]
    v_mfma_f32_16x16x32_bf16 a[76:79], v[128:131], v[144:147], a[76:79]
    buffer_load_dwordx4 v[124:127], v4, s[4:7], s51 offen offset:3072
    buffer_load_dwordx4 v[128:131], v33, s[4:7], s51 offen
    buffer_load_dwordx4 v[132:135], v8, s[8:11], s63 offen
    buffer_load_dwordx4 v[136:139], v9, s[8:11], s63 offen
    buffer_load_dwordx4 v[140:143], v10, s[8:11], s63 offen
    buffer_load_dwordx4 v[144:147], v11, s[8:11], s63 offen
    s_waitcnt vmcnt(18)
    v_mfma_f32_16x16x32_bf16 a[0:3], v[40:43], v[60:63], a[0:3]
    v_mfma_f32_16x16x32_bf16 a[20:23], v[40:43], v[64:67], a[20:23]
    v_mfma_f32_16x16x32_bf16 a[40:43], v[40:43], v[68:71], a[40:43]
    v_mfma_f32_16x16x32_bf16 a[60:63], v[40:43], v[72:75], a[60:63]
    v_mfma_f32_16x16x32_bf16 a[4:7], v[44:47], v[60:63], a[4:7]
    v_mfma_f32_16x16x32_bf16 a[24:27], v[44:47], v[64:67], a[24:27]
    v_mfma_f32_16x16x32_bf16 a[44:47], v[44:47], v[68:71], a[44:47]
    v_mfma_f32_16x16x32_bf16 a[64:67], v[44:47], v[72:75], a[64:67]
    v_mfma_f32_16x16x32_bf16 a[8:11], v[48:51], v[60:63], a[8:11]
    v_mfma_f32_16x16x32_bf16 a[28:31], v[48:51], v[64:67], a[28:31]
    v_mfma_f32_16x16x32_bf16 a[48:51], v[48:51], v[68:71], a[48:51]
    v_mfma_f32_16x16x32_bf16 a[68:71], v[48:51], v[72:75], a[68:71]
    v_mfma_f32_16x16x32_bf16 a[12:15], v[52:55], v[60:63], a[12:15]
    v_mfma_f32_16x16x32_bf16 a[32:35], v[52:55], v[64:67], a[32:35]
    v_mfma_f32_16x16x32_bf16 a[52:55], v[52:55], v[68:71], a[52:55]
    v_mfma_f32_16x16x32_bf16 a[72:75], v[52:55], v[72:75], a[72:75]
    v_mfma_f32_16x16x32_bf16 a[16:19], v[56:59], v[60:63], a[16:19]
    v_mfma_f32_16x16x32_bf16 a[36:39], v[56:59], v[64:67], a[36:39]
    v_mfma_f32_16x16x32_bf16 a[56:59], v[56:59], v[68:71], a[56:59]
    v_mfma_f32_16x16x32_bf16 a[76:79], v[56:59], v[72:75], a[76:79]
    s_waitcnt vmcnt(9)
    v_mfma_f32_16x16x32_bf16 a[0:3], v[76:79], v[96:99], a[0:3]
    v_mfma_f32_16x16x32_bf16 a[20:23], v[76:79], v[100:103], a[20:23]
    v_mfma_f32_16x16x32_bf16 a[40:43], v[76:79], v[104:107], a[40:43]
    v_mfma_f32_16x16x32_bf16 a[60:63], v[76:79], v[108:111], a[60:63]
    v_mfma_f32_16x16x32_bf16 a[4:7], v[80:83], v[96:99], a[4:7]
    v_mfma_f32_16x16x32_bf16 a[24:27], v[80:83], v[100:103], a[24:27]
    v_mfma_f32_16x16x32_bf16 a[44:47], v[80:83], v[104:107], a[44:47]
    v_mfma_f32_16x16x32_bf16 a[64:67], v[80:83], v[108:111], a[64:67]
    v_mfma_f32_16x16x32_bf16 a[8:11], v[84:87], v[96:99], a[8:11]
    v_mfma_f32_16x16x32_bf16 a[28:31], v[84:87], v[100:103], a[28:31]
    v_mfma_f32_16x16x32_bf16 a[48:51], v[84:87], v[104:107], a[48:51]
    v_mfma_f32_16x16x32_bf16 a[68:71], v[84:87], v[108:111], a[68:71]
    v_mfma_f32_16x16x32_bf16 a[12:15], v[88:91], v[96:99], a[12:15]
    v_mfma_f32_16x16x32_bf16 a[32:35], v[88:91], v[100:103], a[32:35]
    v_mfma_f32_16x16x32_bf16 a[52:55], v[88:91], v[104:107], a[52:55]
    v_mfma_f32_16x16x32_bf16 a[72:75], v[88:91], v[108:111], a[72:75]
    v_mfma_f32_16x16x32_bf16 a[16:19], v[92:95], v[96:99], a[16:19]
    v_mfma_f32_16x16x32_bf16 a[36:39], v[92:95], v[100:103], a[36:39]
    v_mfma_f32_16x16x32_bf16 a[56:59], v[92:95], v[104:107], a[56:59]
    v_mfma_f32_16x16x32_bf16 a[76:79], v[92:95], v[108:111], a[76:79]
    s_waitcnt vmcnt(0)
    v_mfma_f32_16x16x32_bf16 a[0:3], v[112:115], v[132:135], a[0:3]
    v_mfma_f32_16x16x32_bf16 a[20:23], v[112:115], v[136:139], a[20:23]
    v_mfma_f32_16x16x32_bf16 a[40:43], v[112:115], v[140:143], a[40:43]
    v_mfma_f32_16x16x32_bf16 a[60:63], v[112:115], v[144:147], a[60:63]
    v_mfma_f32_16x16x32_bf16 a[4:7], v[116:119], v[132:135], a[4:7]
    v_mfma_f32_16x16x32_bf16 a[24:27], v[116:119], v[136:139], a[24:27]
    v_mfma_f32_16x16x32_bf16 a[44:47], v[116:119], v[140:143], a[44:47]
    v_mfma_f32_16x16x32_bf16 a[64:67], v[116:119], v[144:147], a[64:67]
    v_mfma_f32_16x16x32_bf16 a[8:11], v[120:123], v[132:135], a[8:11]
    v_mfma_f32_16x16x32_bf16 a[28:31], v[120:123], v[136:139], a[28:31]
    v_mfma_f32_16x16x32_bf16 a[48:51], v[120:123], v[140:143], a[48:51]
    v_mfma_f32_16x16x32_bf16 a[68:71], v[120:123], v[144:147], a[68:71]
    v_mfma_f32_16x16x32_bf16 a[12:15], v[124:127], v[132:135], a[12:15]
    v_mfma_f32_16x16x32_bf16 a[32:35], v[124:127], v[136:139], a[32:35]
    v_mfma_f32_16x16x32_bf16 a[52:55], v[124:127], v[140:143], a[52:55]
    v_mfma_f32_16x16x32_bf16 a[72:75], v[124:127], v[144:147], a[72:75]
    v_mfma_f32_16x16x32_bf16 a[16:19], v[128:131], v[132:135], a[16:19]
    v_mfma_f32_16x16x32_bf16 a[36:39], v[128:131], v[136:139], a[36:39]
    v_mfma_f32_16x16x32_bf16 a[56:59], v[128:131], v[140:143], a[56:59]
    v_mfma_f32_16x16x32_bf16 a[76:79], v[128:131], v[144:147], a[76:79]
    s_xor_b32 s38, s30, 1
    s_mul_i32 s38, s38, 15360
    s_add_u32 s38, s38, 12288
    v_add_u32 v41, s38, v4
    s_xor_b32 s38, s30, 2
    s_mul_i32 s38, s38, 15360
    s_add_u32 s38, s38, 17408
    v_add_u32 v42, s38, v4
    s_xor_b32 s38, s30, 3
    s_mul_i32 s38, s38, 15360
    s_add_u32 s38, s38, 22528
    v_add_u32 v43, s38, v4
    s_mul_i32 s38, s30, 15360
    s_add_u32 s38, s38, 12288
    v_add_u32 v40, s38, v4
    v_and_b32 v44, 15, v1
    v_lshrrev_b32 v45, 2, v44
    v_and_b32 v46, 3, v44
    v_lshl_add_u32 v45, v5, 2, v45
    v_lshlrev_b32 v45, 7, v45
    v_lshl_add_u32 v45, v46, 3, v45
    s_lshl_b32 s38, s30, 5
    v_add_u32 v45, s38, v45
    v_mul_u32_u24 v46, 1280, v44
    v_lshl_add_u32 v46, v5, 3, v46
    s_lshl_b32 s38, s33, 6
    s_lshl_b32 s39, s30, 4
    s_add_u32 s38, s38, s39
    s_mul_i32 s38, s38, 1280
    s_mul_i32 s39, s34, 160
    s_add_u32 s70, s38, s39
    s_nop 4
    ds_write_b128 v41, a[20:23] offset:0
    ds_write_b128 v41, a[24:27] offset:1024
    ds_write_b128 v41, a[28:31] offset:2048
    ds_write_b128 v41, a[32:35] offset:3072
    ds_write_b128 v41, a[36:39] offset:4096
    ds_write_b128 v42, a[40:43] offset:0
    ds_write_b128 v42, a[44:47] offset:1024
    ds_write_b128 v42, a[48:51] offset:2048
    ds_write_b128 v42, a[52:55] offset:3072
    ds_write_b128 v42, a[56:59] offset:4096
    ds_write_b128 v43, a[60:63] offset:0
    ds_write_b128 v43, a[64:67] offset:1024
    ds_write_b128 v43, a[68:71] offset:2048
    ds_write_b128 v43, a[72:75] offset:3072
    ds_write_b128 v43, a[76:79] offset:4096
    v_accvgpr_read_b32 v60, a0
    v_accvgpr_read_b32 v61, a1
    v_accvgpr_read_b32 v62, a2
    v_accvgpr_read_b32 v63, a3
    v_accvgpr_read_b32 v64, a4
    v_accvgpr_read_b32 v65, a5
    v_accvgpr_read_b32 v66, a6
    v_accvgpr_read_b32 v67, a7
    v_accvgpr_read_b32 v68, a8
    v_accvgpr_read_b32 v69, a9
    v_accvgpr_read_b32 v70, a10
    v_accvgpr_read_b32 v71, a11
    v_accvgpr_read_b32 v72, a12
    v_accvgpr_read_b32 v73, a13
    v_accvgpr_read_b32 v74, a14
    v_accvgpr_read_b32 v75, a15
    v_accvgpr_read_b32 v76, a16
    v_accvgpr_read_b32 v77, a17
    v_accvgpr_read_b32 v78, a18
    v_accvgpr_read_b32 v79, a19
    s_waitcnt lgkmcnt(0)
    s_barrier
    ds_read_b128 v[80:83], v40 offset:0
    ds_read_b128 v[84:87], v40 offset:1024
    ds_read_b128 v[88:91], v40 offset:2048
    ds_read_b128 v[92:95], v40 offset:3072
    ds_read_b128 v[96:99], v40 offset:4096
    ds_read_b128 v[100:103], v40 offset:5120
    ds_read_b128 v[104:107], v40 offset:6144
    ds_read_b128 v[108:111], v40 offset:7168
    ds_read_b128 v[112:115], v40 offset:8192
    ds_read_b128 v[116:119], v40 offset:9216
    ds_read_b128 v[120:123], v40 offset:10240
    ds_read_b128 v[124:127], v40 offset:11264
    ds_read_b128 v[128:131], v40 offset:12288
    ds_read_b128 v[132:135], v40 offset:13312
    ds_read_b128 v[136:139], v40 offset:14336
    s_waitcnt lgkmcnt(10)
    ds_read_b64_tr_b16 v[140:141], v45 offset:0
    ds_read_b64_tr_b16 v[142:143], v45 offset:2048
    ds_read_b64_tr_b16 v[144:145], v45 offset:4096
    ds_read_b64_tr_b16 v[146:147], v45 offset:6144
    ds_read_b64_tr_b16 v[148:149], v45 offset:8192
    s_waitcnt lgkmcnt(10)
    v_add_f32 v60, v60, v80
    v_add_f32 v61, v61, v81
    v_add_f32 v62, v62, v82
    v_add_f32 v63, v63, v83
    v_add_f32 v64, v64, v84
    v_add_f32 v65, v65, v85
    v_add_f32 v66, v66, v86
    v_add_f32 v67, v67, v87
    v_add_f32 v68, v68, v88
    v_add_f32 v69, v69, v89
    v_add_f32 v70, v70, v90
    v_add_f32 v71, v71, v91
    v_add_f32 v72, v72, v92
    v_add_f32 v73, v73, v93
    v_add_f32 v74, v74, v94
    v_add_f32 v75, v75, v95
    v_add_f32 v76, v76, v96
    v_add_f32 v77, v77, v97
    v_add_f32 v78, v78, v98
    v_add_f32 v79, v79, v99
    s_waitcnt lgkmcnt(5)
    v_add_f32 v100, v100, v120
    v_add_f32 v101, v101, v121
    v_add_f32 v102, v102, v122
    v_add_f32 v103, v103, v123
    v_add_f32 v104, v104, v124
    v_add_f32 v105, v105, v125
    v_add_f32 v106, v106, v126
    v_add_f32 v107, v107, v127
    v_add_f32 v108, v108, v128
    v_add_f32 v109, v109, v129
    v_add_f32 v110, v110, v130
    v_add_f32 v111, v111, v131
    v_add_f32 v112, v112, v132
    v_add_f32 v113, v113, v133
    v_add_f32 v114, v114, v134
    v_add_f32 v115, v115, v135
    v_add_f32 v116, v116, v136
    v_add_f32 v117, v117, v137
    v_add_f32 v118, v118, v138
    v_add_f32 v119, v119, v139
    v_add_f32 v60, v60, v100
    v_add_f32 v61, v61, v101
    v_add_f32 v62, v62, v102
    v_add_f32 v63, v63, v103
    v_add_f32 v64, v64, v104
    v_add_f32 v65, v65, v105
    v_add_f32 v66, v66, v106
    v_add_f32 v67, v67, v107
    v_add_f32 v68, v68, v108
    v_add_f32 v69, v69, v109
    v_add_f32 v70, v70, v110
    v_add_f32 v71, v71, v111
    v_add_f32 v72, v72, v112
    v_add_f32 v73, v73, v113
    v_add_f32 v74, v74, v114
    v_add_f32 v75, v75, v115
    v_add_f32 v76, v76, v116
    v_add_f32 v77, v77, v117
    v_add_f32 v78, v78, v118
    v_add_f32 v79, v79, v119
    s_waitcnt lgkmcnt(0)
    v_lshlrev_b32 v50, 16, v140
    v_and_b32 v51, 0xffff0000, v140
    v_fma_f32 v50, v60, v12, v50
    v_fma_f32 v51, v61, v13, v51
    v_cvt_pk_bf16_f32 v150, v50, v51
    v_lshlrev_b32 v50, 16, v141
    v_and_b32 v51, 0xffff0000, v141
    v_fma_f32 v50, v62, v14, v50
    v_fma_f32 v51, v63, v15, v51
    v_cvt_pk_bf16_f32 v151, v50, v51
    buffer_store_dwordx2 v[150:151], v46, s[20:23], s70 offen offset:0
    v_lshlrev_b32 v50, 16, v142
    v_and_b32 v51, 0xffff0000, v142
    v_fma_f32 v50, v64, v16, v50
    v_fma_f32 v51, v65, v17, v51
    v_cvt_pk_bf16_f32 v152, v50, v51
    v_lshlrev_b32 v50, 16, v143
    v_and_b32 v51, 0xffff0000, v143
    v_fma_f32 v50, v66, v18, v50
    v_fma_f32 v51, v67, v19, v51
    v_cvt_pk_bf16_f32 v153, v50, v51
    buffer_store_dwordx2 v[152:153], v46, s[20:23], s70 offen offset:32
    v_lshlrev_b32 v50, 16, v144
    v_and_b32 v51, 0xffff0000, v144
    v_fma_f32 v50, v68, v20, v50
    v_fma_f32 v51, v69, v21, v51
    v_cvt_pk_bf16_f32 v154, v50, v51
    v_lshlrev_b32 v50, 16, v145
    v_and_b32 v51, 0xffff0000, v145
    v_fma_f32 v50, v70, v22, v50
    v_fma_f32 v51, v71, v23, v51
    v_cvt_pk_bf16_f32 v155, v50, v51
    buffer_store_dwordx2 v[154:155], v46, s[20:23], s70 offen offset:64
    v_lshlrev_b32 v50, 16, v146
    v_and_b32 v51, 0xffff0000, v146
    v_fma_f32 v50, v72, v24, v50
    v_fma_f32 v51, v73, v25, v51
    v_cvt_pk_bf16_f32 v156, v50, v51
    v_lshlrev_b32 v50, 16, v147
    v_and_b32 v51, 0xffff0000, v147
    v_fma_f32 v50, v74, v26, v50
    v_fma_f32 v51, v75, v27, v51
    v_cvt_pk_bf16_f32 v157, v50, v51
    buffer_store_dwordx2 v[156:157], v46, s[20:23], s70 offen offset:96
    v_lshlrev_b32 v50, 16, v148
    v_and_b32 v51, 0xffff0000, v148
    v_fma_f32 v50, v76, v28, v50
    v_fma_f32 v51, v77, v29, v51
    v_cvt_pk_bf16_f32 v158, v50, v51
    v_lshlrev_b32 v50, 16, v149
    v_and_b32 v51, 0xffff0000, v149
    v_fma_f32 v50, v78, v30, v50
    v_fma_f32 v51, v79, v31, v51
    v_cvt_pk_bf16_f32 v159, v50, v51
    buffer_store_dwordx2 v[158:159], v46, s[20:23], s70 offen offset:128
    s_endpgm
K4_END:
.section .rodata,"a"
.p2align 6
.amdhsa_kernel k12_prep_kernel
  .amdhsa_next_free_vgpr 256
  .amdhsa_next_free_sgpr 102
  .amdhsa_accum_offset 256
  .amdhsa_group_segment_fixed_size 0
  .amdhsa_kernarg_size 128
  .amdhsa_user_sgpr_count 2
  .amdhsa_user_sgpr_kernarg_segment_ptr 1
  .amdhsa_system_sgpr_workgroup_id_x 1
.end_amdhsa_kernel
.section .rodata,"a"
.p2align 6
.amdhsa_kernel k3_gemm1_kernel
  .amdhsa_next_free_vgpr 256
  .amdhsa_next_free_sgpr 102
  .amdhsa_accum_offset 256
  .amdhsa_group_segment_fixed_size 0
  .amdhsa_kernarg_size 128
  .amdhsa_user_sgpr_count 2
  .amdhsa_user_sgpr_kernarg_segment_ptr 1
  .amdhsa_system_sgpr_workgroup_id_x 1
.end_amdhsa_kernel
.section .rodata,"a"
.p2align 6
.amdhsa_kernel k4_gemm2_kernel
  .amdhsa_next_free_vgpr 336
  .amdhsa_next_free_sgpr 102
  .amdhsa_accum_offset 256
  .amdhsa_group_segment_fixed_size 0
  .amdhsa_kernarg_size 128
  .amdhsa_user_sgpr_count 2
  .amdhsa_user_sgpr_kernarg_segment_ptr 1
  .amdhsa_system_sgpr_workgroup_id_x 1
.end_amdhsa_kernel
```
